```python
import torch

def _softmax(x, axis=-1):
    return torch.softmax(x, dim=axis)
def _gelu(x):
    return torch.nn.functional.gelu(x, approximate="tanh")
def _silu(x):
    return torch.nn.functional.silu(x)
def _sigmoid(x):
    return torch.sigmoid(x)
def _layernorm(x, axis=-1, eps=1e-5):
    m = x.mean(dim=axis, keepdim=True)
    v = x.var(dim=axis, keepdim=True, unbiased=False)
    return (x - m) / torch.sqrt(v + eps)
def _scatter_add(tgt, idx, src, axis=0):
    return tgt.clone().index_add_(axis, idx, src)
def _segment_sum(src, seg, n):
    out = torch.zeros((n,) + src.shape[1:], dtype=src.dtype)
    return out.index_add_(0, seg, src)
def _pad(x, pw):
    flat = tuple(v for pair in reversed(pw) for v in pair)
    return torch.nn.functional.pad(x, flat)

kernel_name = 'parallel_sum__linear_kernel_hedgehog__mixer_token_mlp__prompt'

def setup_inputs():

    _w = (lambda a: (lambda t: t.to(torch.bfloat16) if t.is_floating_point() else t)(torch.as_tensor(a)))
    def _A_setup():
        B, S, D, H = 1, 2048, 512, 32
        Dh = D // H
        return {
            "x": _w((lambda *s: torch.randn(*s, dtype=torch.bfloat16) * 0.05)(B, S, D)),
            "wqkv": _w((lambda *s: torch.randn(*s, dtype=torch.bfloat16) * 0.2)(D, 3 * D)),
            "w_phi": _w((lambda *s: torch.randn(*s, dtype=torch.bfloat16) * 0.2)(H, Dh, Dh) * (Dh ** -0.5)),
            "wo": _w((lambda *s: torch.randn(*s, dtype=torch.bfloat16) * 0.05)(D, D)),
        }
    _A_in = _A_setup()

    def _B_setup():
        B, S, D, F = 1, 2048, 512, 1376
        return {
            "x": _w((lambda *s: torch.randn(*s, dtype=torch.bfloat16) * 0.05)(B, S, D)),
            "w1": _w((lambda *s: torch.randn(*s, dtype=torch.bfloat16) * 0.8)(S, F) * (S ** -0.5)),
            "b1": _w((lambda *s: torch.randn(*s, dtype=torch.bfloat16) * 3.2)(F) * 0.02),
            "w2": _w((lambda *s: torch.randn(*s, dtype=torch.bfloat16) * 0.4)(F, S) * (F ** -0.5)),
            "b2": _w((lambda *s: torch.randn(*s, dtype=torch.bfloat16) * 1.6)(S) * 0.02),
        }
    _B_in = _B_setup()

    return {
        "A_x": _A_in["x"],
        "A_wqkv": _A_in["wqkv"],
        "A_w_phi": _A_in["w_phi"],
        "A_wo": _A_in["wo"],
        "B_x": _B_in["x"],
        "B_w1": _B_in["w1"],
        "B_b1": _B_in["b1"],
        "B_w2": _B_in["w2"],
        "B_b2": _B_in["b2"],
    }

def reference(A_x, A_wqkv, A_w_phi, A_wo, B_x, B_w1, B_b1, B_w2, B_b2):
    def _A_ref(x, wqkv, w_phi, wo):
        B, S, D = x.shape
        H = 32; Dh = D // H
        qkv = (lambda x, *d: x.permute(*d))((x @ wqkv).reshape(B, S, 3, H, Dh), 2, 0, 3, 1, 4)
        q, k, v = qkv[0], qkv[1], qkv[2]
        pq = torch.einsum("bhsd,hdf->bhsf", q, w_phi)
        pk = torch.einsum("bhsd,hdf->bhsf", k, w_phi)
        phi_q = torch.concatenate([_softmax(pq, axis=-1), _softmax(-pq, axis=-1)], axis=-1)
        phi_k = torch.concatenate([_softmax(pk, axis=-1), _softmax(-pk, axis=-1)], axis=-1)
        kv = torch.einsum("bhsf,bhsd->bhfd", phi_k, v)
        z  = torch.einsum("bhsf->bhf", phi_k)
        num = torch.einsum("bhqf,bhfd->bhqd", phi_q, kv)
        den = torch.einsum("bhqf,bhf->bhq", phi_q, z)[..., None] + 1e-6
        o = num / den
        return (lambda x, *d: x.permute(*d))(o, 0, 2, 1, 3).reshape(B, S, D) @ wo

    def _B_ref(x, w1, b1, w2, b2):
        B, S, D = x.shape
        h = _layernorm(x, axis=-1)
        u = torch.einsum("bsd,sf->bdf", h, w1) + b1
        u = _gelu(u)
        y = torch.einsum("bdf,fs->bds", u, w2) + b2
        return (lambda x, *d: x.permute(*d))(y, 0, 2, 1)

    x = A_x
    xn = _layernorm(x, axis=-1)
    return x + _A_ref(xn, A_wqkv, A_w_phi, A_wo) + _B_ref(xn, B_w1, B_b1, B_w2, B_b2)
```

```asm
; @launch grid=(256,1,1) block=(448,1,1) lds=163840
.amdgcn_target "amdgcn-amd-amdhsa--gfx950"
.text
.globl parallel_sum__linear_kernel_hedgehog__mixer_token_mlp__prompt_kernel
.p2align 8
.type parallel_sum__linear_kernel_hedgehog__mixer_token_mlp__prompt_kernel,@function
parallel_sum__linear_kernel_hedgehog__mixer_token_mlp__prompt_kernel:
    s_cmp_ge_u32 s2, 256
    s_cbranch_scc1 L_END
    s_load_dwordx16 s[4:19], s[0:1], 0
    s_load_dwordx8 s[20:27], s[0:1], 64
L_PC:
    s_getpc_b64 s[48:49]
    v_and_b32 v144, 63, v0
    v_lshrrev_b32 v153, 6, v0
    s_nop 0
    v_readfirstlane_b32 s60, v153
    s_and_b32 s72, s2, 7
    s_lshr_b32 s73, s2, 3
    s_cmp_eq_u32 s60, 6
    s_nop 1
    s_cbranch_scc1 L_HELP
    s_lshl_b32 s63, s72, 5
    s_add_u32 s63, s63, s73
    s_lshr_b32 s61, s72, 1
    s_lshl_b32 s61, s61, 3
    s_lshr_b32 s66, s73, 2
    s_add_u32 s61, s61, s66
    s_and_b32 s62, s72, 1
    s_lshl_b32 s62, s62, 2
    s_and_b32 s66, s73, 3
    s_add_u32 s62, s62, s66
    v_lshlrev_b32 v157, 4, v144
    v_lshrrev_b32 v148, 4, v144
    v_lshrrev_b32 v151, 3, v144
    v_and_b32 v152, 7, v144
    s_cmp_ge_u32 s60, 4
    s_nop 0
    s_cbranch_scc1 L_LOAD
    s_setprio 2
    s_lshl_b32 s67, s60, 11
    v_and_b32 v145, 31, v144
    v_lshrrev_b32 v146, 5, v144
    v_lshlrev_b32 v156, 10, v146
    v_lshl_add_u32 v156, v145, 4, v156
    s_lshl_b32 s64, s63, 13
    s_add_u32 s64, s64, s67
    s_waitcnt lgkmcnt(0)
    s_mov_b32 s28, s4
    s_mov_b32 s29, s5
    s_mov_b32 s30, 2097152
    s_mov_b32 s31, 0x20000
    buffer_load_dwordx4 v[160:163], v156, s[28:31], s64 offen
    buffer_load_dwordx4 v[164:167], v156, s[28:31], s64 offen offset:512
    s_mov_b32 s40, s26
    s_mov_b32 s41, s27
    s_mov_b32 s42, 25165824
    s_mov_b32 s43, 0x20000
    s_mov_b32 s52, s24
    s_mov_b32 s53, s25
    s_mov_b32 s54, 256
    s_mov_b32 s55, 0x20000
    s_mov_b32 s79, 1069066811
    v_and_b32 v147, 15, v144
    v_bfe_u32 v149, v144, 2, 2
    v_and_b32 v150, 3, v144
    s_and_b32 s64, s60, 1
    s_lshr_b32 s65, s60, 1
    v_bfe_u32 v153, v144, 1, 3
    v_xor_b32 v153, v153, v146
    v_lshlrev_b32 v153, 4, v153
    v_lshl_add_u32 v153, v145, 7, v153
    s_lshl_b32 s66, s64, 12
    v_add_u32 v128, s66, v153
    v_xor_b32 v129, 32, v128
    v_xor_b32 v130, 64, v128
    v_xor_b32 v131, 96, v128
    v_bfe_u32 v153, v144, 3, 1
    v_lshlrev_b32 v153, 2, v153
    v_and_b32 v154, 1, v144
    v_lshlrev_b32 v154, 3, v154
    v_lshl_add_u32 v154, v149, 7, v154
    v_bfe_u32 v155, v144, 4, 1
    v_lshlrev_b32 v155, 1, v155
    v_bfe_u32 v134, v144, 1, 1
    v_add_u32 v155, v155, v134
    s_lshl_b32 s66, s65, 2
    v_add_u32 v155, s66, v155
    v_xor_b32 v155, v155, v153
    v_lshl_add_u32 v155, v155, 4, v154
    v_add_u32 v155, 65536, v155
    v_lshl_add_u32 v134, v146, 11, v155
    v_lshl_add_u32 v135, v146, 10, v155
    v_bfe_u32 v155, v144, 1, 1
    s_lshl_b32 s66, s60, 1
    v_add_u32 v155, s66, v155
    v_xor_b32 v155, v155, v153
    v_lshl_add_u32 v155, v155, 4, v154
    v_add_u32 v155, 65536, v155
    v_lshl_add_u32 v136, v148, 11, v155
    v_lshl_add_u32 v137, v148, 10, v155
    v_bfe_u32 v153, v144, 1, 3
    v_xor_b32 v153, v153, v148
    v_lshlrev_b32 v153, 4, v153
    v_lshl_add_u32 v153, v147, 7, v153
    v_add_u32 v132, s67, v153
    v_xor_b32 v133, 64, v132
    v_mov_b32 v68, 1065369472
    v_mov_b32 v69, 1065369472
    v_mov_b32 v70, 1065369472
    v_mov_b32 v71, 1065369472
    s_lshl_b32 s64, s60, 1
    s_add_u32 s64, s64, 128
    v_add_u32 v153, s64, v146
    v_and_b32 v154, 3, v153
    v_lshlrev_b32 v154, 6, v154
    v_lshl_add_u32 v154, v145, 4, v154
    v_lshl_add_u32 v174, v153, 10, v154
    v_add_u32 v154, 512, v154
    v_and_b32 v154, 1023, v154
    v_lshl_add_u32 v175, v153, 10, v154
    v_lshlrev_b32 v153, 5, v148
    v_lshl_add_u32 v153, v150, 3, v153
    s_lshl_b32 s64, s60, 8
    v_lshl_add_u32 v154, v149, 6, v153
    v_add_u32 v154, s64, v154
    v_add_u32 v155, 128, v154
    v_and_b32 v154, 1023, v154
    v_and_b32 v155, 1023, v155
    v_add_u32 v153, 128, v149
    v_lshl_add_u32 v176, v153, 10, v154
    v_lshl_add_u32 v177, v153, 10, v155
    s_and_b32 s64, s63, 3
    s_lshl_b32 s64, s64, 8
    s_lshr_b32 s65, s63, 2
    s_lshl_b32 s65, s65, 10
    s_add_u32 s64, s64, s65
    v_lshlrev_b32 v179, 16, v148
    v_lshl_add_u32 v179, v147, 4, v179
    v_add_u32 v179, s64, v179
    v_lshl_add_u32 v180, v146, 2, v149
    v_lshlrev_b32 v180, 5, v180
    v_lshl_add_u32 v180, v150, 3, v180
    s_lshr_b32 s64, s60, 1
    s_lshl_b32 s64, s64, 10
    s_add_u32 s64, s64, 161792
    v_add_u32 v180, s64, v180
    v_bfe_u32 v181, v144, 4, 1
    v_mul_u32_u24 v181, 0x8000, v181
    v_lshl_or_b32 v181, v181, 16, v181
    s_lshl_b32 s66, s62, 2
    s_add_u32 s66, s66, s60
    s_lshl_b32 s64, s61, 5
    s_add_u32 s88, s66, s64
    s_mul_i32 s86, s88, 640
    s_add_u32 s86, s86, 17825792
    s_mul_i32 s88, s88, 1088
    s_add_u32 s88, s88, 8388608
    v_mul_u32_u24 v156, 17, v146
    v_add_lshl_u32 v156, v156, v145, 4
    v_mov_b32 v248, 19922944
    v_writelane_b32 v248, s86, 2
    s_lshr_b32 s12, s72, 1
    s_and_b32 s64, s72, 1
    s_mul_i32 s13, s64, 30
    s_add_u32 s13, s13, s73
    s_lshl_b32 s65, s72, 1
    s_add_u32 s65, s65, s73
    s_sub_u32 s65, s65, 30
    s_cmp_ge_u32 s73, 30
    s_cselect_b32 s83, s65, -1
    s_cselect_b32 s13, 60, s13
    s_lshr_b32 s75, s13, 2
    s_and_b32 s74, s13, 3
    s_lshl_b32 s64, s13, 2
    s_add_u32 s64, s64, s60
    s_lshl_b32 s64, s64, 2
    s_add_u32 s64, s64, s12
    s_mul_i32 s70, s64, 6144
    s_add_u32 s70, s70, 2097152
    s_add_u32 s71, s70, 4096
    s_mul_i32 s64, s64, 640
    s_add_u32 s64, s64, 18874368
    v_writelane_b32 v248, s64, 3
    s_lshl_b32 s64, s74, 3
    s_and_b32 s65, s12, 1
    s_lshl_b32 s65, s65, 2
    s_add_u32 s64, s64, s65
    s_add_u32 s0, s64, s60
    s_lshl_b32 s65, s75, 1
    s_lshr_b32 s66, s12, 1
    s_add_u32 s1, s65, s66
    s_lshl_b32 s64, s0, 5
    s_add_u32 s64, s64, s1
    s_mul_i32 s64, s64, 640
    s_add_u32 s64, s64, 16777216
    v_writelane_b32 v248, s64, 1
    v_mov_b32 v184, -1
    v_mov_b32 v185, -1
    v_mov_b32 v186, -1
    v_mov_b32 v187, -1
    s_lshl_b32 s81, s60, 19
    s_add_u32 s82, s81, 262144
    s_lshl_b32 s87, s2, 8
    s_lshl_b32 s64, s60, 6
    s_add_u32 s87, s87, s64
    s_add_u32 s87, s87, 11534336
    s_waitcnt vmcnt(0)
    v_mov_b32 v168, 0
    v_mov_b32 v169, 0
    v_dot2c_f32_bf16 v168, v68, v160
    v_dot2c_f32_bf16 v169, v160, v160
    v_dot2c_f32_bf16 v168, v68, v161
    v_dot2c_f32_bf16 v169, v161, v161
    v_dot2c_f32_bf16 v168, v68, v162
    v_dot2c_f32_bf16 v169, v162, v162
    v_dot2c_f32_bf16 v168, v68, v163
    v_dot2c_f32_bf16 v169, v163, v163
    v_dot2c_f32_bf16 v168, v68, v164
    v_dot2c_f32_bf16 v169, v164, v164
    v_dot2c_f32_bf16 v168, v68, v165
    v_dot2c_f32_bf16 v169, v165, v165
    v_dot2c_f32_bf16 v168, v68, v166
    v_dot2c_f32_bf16 v169, v166, v166
    v_dot2c_f32_bf16 v168, v68, v167
    v_dot2c_f32_bf16 v169, v167, v167
    v_lshlrev_b32 v192, 16, v160
    v_and_b32 v193, 0xffff0000, v160
    v_lshlrev_b32 v194, 16, v161
    v_and_b32 v195, 0xffff0000, v161
    v_lshlrev_b32 v196, 16, v162
    v_and_b32 v197, 0xffff0000, v162
    v_lshlrev_b32 v198, 16, v163
    v_and_b32 v199, 0xffff0000, v163
    v_lshlrev_b32 v200, 16, v164
    v_and_b32 v201, 0xffff0000, v164
    v_lshlrev_b32 v202, 16, v165
    v_and_b32 v203, 0xffff0000, v165
    v_lshlrev_b32 v204, 16, v166
    v_and_b32 v205, 0xffff0000, v166
    v_lshlrev_b32 v206, 16, v167
    v_and_b32 v207, 0xffff0000, v167
    v_add_f32_dpp v168, v168, v168 quad_perm:[1,0,3,2] row_mask:0xf bank_mask:0xf
    v_add_f32_dpp v169, v169, v169 quad_perm:[1,0,3,2] row_mask:0xf bank_mask:0xf
    s_nop 0
    v_add_f32_dpp v168, v168, v168 quad_perm:[2,3,0,1] row_mask:0xf bank_mask:0xf
    v_add_f32_dpp v169, v169, v169 quad_perm:[2,3,0,1] row_mask:0xf bank_mask:0xf
    s_nop 0
    v_add_f32_dpp v168, v168, v168 row_half_mirror row_mask:0xf bank_mask:0xf
    v_add_f32_dpp v169, v169, v169 row_half_mirror row_mask:0xf bank_mask:0xf
    s_nop 0
    v_add_f32_dpp v168, v168, v168 row_mirror row_mask:0xf bank_mask:0xf
    v_add_f32_dpp v169, v169, v169 row_mirror row_mask:0xf bank_mask:0xf
    v_mov_b32 v172, v168
    v_mov_b32 v173, v169
    s_nop 0
    v_permlane16_swap_b32 v168, v172
    v_permlane16_swap_b32 v169, v173
    v_add_f32 v168, v168, v172
    v_add_f32 v169, v169, v173
    v_mul_f32 v168, 0x3b000000, v168
    v_mul_f32 v169, 0x3b000000, v169
    v_fma_f32 v169, -v168, v168, v169
    v_max_f32 v169, 0, v169
    v_cvt_pk_bf16_f32 v170, v168, v168
    v_and_b32 v170, 0xffff0000, v170
    v_cvt_pk_bf16_f32 v172, v169, v169
    v_and_b32 v172, 0xffff0000, v172
    v_add_f32 v172, 0x3727c5ac, v172
    v_cvt_pk_bf16_f32 v172, v172, v172
    v_and_b32 v172, 0xffff0000, v172
    v_sqrt_f32 v172, v172
    s_nop 0
    v_cvt_pk_bf16_f32 v172, v172, v172
    v_and_b32 v172, 0xffff0000, v172
    v_rcp_f32 v171, v172
    s_nop 0
    v_pk_add_f32 v[192:193], v[192:193], v[170:171] op_sel_hi:[1,0] neg_lo:[0,1] neg_hi:[0,1]
    v_pk_add_f32 v[194:195], v[194:195], v[170:171] op_sel_hi:[1,0] neg_lo:[0,1] neg_hi:[0,1]
    v_pk_add_f32 v[196:197], v[196:197], v[170:171] op_sel_hi:[1,0] neg_lo:[0,1] neg_hi:[0,1]
    v_pk_add_f32 v[198:199], v[198:199], v[170:171] op_sel_hi:[1,0] neg_lo:[0,1] neg_hi:[0,1]
    v_pk_add_f32 v[200:201], v[200:201], v[170:171] op_sel_hi:[1,0] neg_lo:[0,1] neg_hi:[0,1]
    v_pk_add_f32 v[202:203], v[202:203], v[170:171] op_sel_hi:[1,0] neg_lo:[0,1] neg_hi:[0,1]
    v_pk_add_f32 v[204:205], v[204:205], v[170:171] op_sel_hi:[1,0] neg_lo:[0,1] neg_hi:[0,1]
    v_pk_add_f32 v[206:207], v[206:207], v[170:171] op_sel_hi:[1,0] neg_lo:[0,1] neg_hi:[0,1]
    v_cvt_pk_bf16_f32 v160, v192, v193
    v_cvt_pk_bf16_f32 v161, v194, v195
    v_cvt_pk_bf16_f32 v162, v196, v197
    v_cvt_pk_bf16_f32 v163, v198, v199
    v_cvt_pk_bf16_f32 v164, v200, v201
    v_cvt_pk_bf16_f32 v165, v202, v203
    v_cvt_pk_bf16_f32 v166, v204, v205
    v_cvt_pk_bf16_f32 v167, v206, v207
    v_lshlrev_b32 v192, 16, v160
    v_and_b32 v193, 0xffff0000, v160
    v_lshlrev_b32 v194, 16, v161
    v_and_b32 v195, 0xffff0000, v161
    v_lshlrev_b32 v196, 16, v162
    v_and_b32 v197, 0xffff0000, v162
    v_lshlrev_b32 v198, 16, v163
    v_and_b32 v199, 0xffff0000, v163
    v_lshlrev_b32 v200, 16, v164
    v_and_b32 v201, 0xffff0000, v164
    v_lshlrev_b32 v202, 16, v165
    v_and_b32 v203, 0xffff0000, v165
    v_lshlrev_b32 v204, 16, v166
    v_and_b32 v205, 0xffff0000, v166
    v_lshlrev_b32 v206, 16, v167
    v_and_b32 v207, 0xffff0000, v167
    v_pk_mul_f32 v[192:193], v[192:193], v[170:171] op_sel:[0,1] op_sel_hi:[1,1]
    v_pk_mul_f32 v[194:195], v[194:195], v[170:171] op_sel:[0,1] op_sel_hi:[1,1]
    v_pk_mul_f32 v[196:197], v[196:197], v[170:171] op_sel:[0,1] op_sel_hi:[1,1]
    v_pk_mul_f32 v[198:199], v[198:199], v[170:171] op_sel:[0,1] op_sel_hi:[1,1]
    v_pk_mul_f32 v[200:201], v[200:201], v[170:171] op_sel:[0,1] op_sel_hi:[1,1]
    v_pk_mul_f32 v[202:203], v[202:203], v[170:171] op_sel:[0,1] op_sel_hi:[1,1]
    v_pk_mul_f32 v[204:205], v[204:205], v[170:171] op_sel:[0,1] op_sel_hi:[1,1]
    v_pk_mul_f32 v[206:207], v[206:207], v[170:171] op_sel:[0,1] op_sel_hi:[1,1]
    v_cvt_pk_bf16_f32 v160, v192, v193
    v_cvt_pk_bf16_f32 v161, v194, v195
    v_cvt_pk_bf16_f32 v162, v196, v197
    v_cvt_pk_bf16_f32 v163, v198, v199
    v_cvt_pk_bf16_f32 v164, v200, v201
    v_cvt_pk_bf16_f32 v165, v202, v203
    v_cvt_pk_bf16_f32 v166, v204, v205
    v_cvt_pk_bf16_f32 v167, v206, v207
    v_mov_b32 v168, 0
    v_mov_b32 v169, 0
    v_dot2c_f32_bf16 v168, v68, v160
    v_dot2c_f32_bf16 v169, v160, v160
    v_dot2c_f32_bf16 v168, v68, v161
    v_dot2c_f32_bf16 v169, v161, v161
    v_dot2c_f32_bf16 v168, v68, v162
    v_dot2c_f32_bf16 v169, v162, v162
    v_dot2c_f32_bf16 v168, v68, v163
    v_dot2c_f32_bf16 v169, v163, v163
    v_dot2c_f32_bf16 v168, v68, v164
    v_dot2c_f32_bf16 v169, v164, v164
    v_dot2c_f32_bf16 v168, v68, v165
    v_dot2c_f32_bf16 v169, v165, v165
    v_dot2c_f32_bf16 v168, v68, v166
    v_dot2c_f32_bf16 v169, v166, v166
    v_dot2c_f32_bf16 v168, v68, v167
    v_dot2c_f32_bf16 v169, v167, v167
    v_lshlrev_b32 v192, 16, v160
    v_and_b32 v193, 0xffff0000, v160
    v_lshlrev_b32 v194, 16, v161
    v_and_b32 v195, 0xffff0000, v161
    v_lshlrev_b32 v196, 16, v162
    v_and_b32 v197, 0xffff0000, v162
    v_lshlrev_b32 v198, 16, v163
    v_and_b32 v199, 0xffff0000, v163
    v_lshlrev_b32 v200, 16, v164
    v_and_b32 v201, 0xffff0000, v164
    v_lshlrev_b32 v202, 16, v165
    v_and_b32 v203, 0xffff0000, v165
    v_lshlrev_b32 v204, 16, v166
    v_and_b32 v205, 0xffff0000, v166
    v_lshlrev_b32 v206, 16, v167
    v_and_b32 v207, 0xffff0000, v167
    v_add_f32_dpp v168, v168, v168 quad_perm:[1,0,3,2] row_mask:0xf bank_mask:0xf
    v_add_f32_dpp v169, v169, v169 quad_perm:[1,0,3,2] row_mask:0xf bank_mask:0xf
    s_nop 0
    v_add_f32_dpp v168, v168, v168 quad_perm:[2,3,0,1] row_mask:0xf bank_mask:0xf
    v_add_f32_dpp v169, v169, v169 quad_perm:[2,3,0,1] row_mask:0xf bank_mask:0xf
    s_nop 0
    v_add_f32_dpp v168, v168, v168 row_half_mirror row_mask:0xf bank_mask:0xf
    v_add_f32_dpp v169, v169, v169 row_half_mirror row_mask:0xf bank_mask:0xf
    s_nop 0
    v_add_f32_dpp v168, v168, v168 row_mirror row_mask:0xf bank_mask:0xf
    v_add_f32_dpp v169, v169, v169 row_mirror row_mask:0xf bank_mask:0xf
    v_mov_b32 v172, v168
    v_mov_b32 v173, v169
    s_nop 0
    v_permlane16_swap_b32 v168, v172
    v_permlane16_swap_b32 v169, v173
    v_add_f32 v168, v168, v172
    v_add_f32 v169, v169, v173
    v_mul_f32 v168, 0x3b000000, v168
    v_mul_f32 v169, 0x3b000000, v169
    v_fma_f32 v169, -v168, v168, v169
    v_max_f32 v169, 0, v169
    v_cvt_pk_bf16_f32 v170, v168, v168
    v_and_b32 v170, 0xffff0000, v170
    v_cvt_pk_bf16_f32 v172, v169, v169
    v_and_b32 v172, 0xffff0000, v172
    v_add_f32 v172, 0x3727c5ac, v172
    v_cvt_pk_bf16_f32 v172, v172, v172
    v_and_b32 v172, 0xffff0000, v172
    v_sqrt_f32 v172, v172
    s_nop 0
    v_cvt_pk_bf16_f32 v172, v172, v172
    v_and_b32 v172, 0xffff0000, v172
    v_rcp_f32 v171, v172
    s_nop 0
    v_pk_add_f32 v[192:193], v[192:193], v[170:171] op_sel_hi:[1,0] neg_lo:[0,1] neg_hi:[0,1]
    v_pk_add_f32 v[194:195], v[194:195], v[170:171] op_sel_hi:[1,0] neg_lo:[0,1] neg_hi:[0,1]
    v_pk_add_f32 v[196:197], v[196:197], v[170:171] op_sel_hi:[1,0] neg_lo:[0,1] neg_hi:[0,1]
    v_pk_add_f32 v[198:199], v[198:199], v[170:171] op_sel_hi:[1,0] neg_lo:[0,1] neg_hi:[0,1]
    v_pk_add_f32 v[200:201], v[200:201], v[170:171] op_sel_hi:[1,0] neg_lo:[0,1] neg_hi:[0,1]
    v_pk_add_f32 v[202:203], v[202:203], v[170:171] op_sel_hi:[1,0] neg_lo:[0,1] neg_hi:[0,1]
    v_pk_add_f32 v[204:205], v[204:205], v[170:171] op_sel_hi:[1,0] neg_lo:[0,1] neg_hi:[0,1]
    v_pk_add_f32 v[206:207], v[206:207], v[170:171] op_sel_hi:[1,0] neg_lo:[0,1] neg_hi:[0,1]
    v_cvt_pk_bf16_f32 v160, v192, v193
    v_cvt_pk_bf16_f32 v161, v194, v195
    v_cvt_pk_bf16_f32 v162, v196, v197
    v_cvt_pk_bf16_f32 v163, v198, v199
    v_cvt_pk_bf16_f32 v164, v200, v201
    v_cvt_pk_bf16_f32 v165, v202, v203
    v_cvt_pk_bf16_f32 v166, v204, v205
    v_cvt_pk_bf16_f32 v167, v206, v207
    v_lshlrev_b32 v192, 16, v160
    v_and_b32 v193, 0xffff0000, v160
    v_lshlrev_b32 v194, 16, v161
    v_and_b32 v195, 0xffff0000, v161
    v_lshlrev_b32 v196, 16, v162
    v_and_b32 v197, 0xffff0000, v162
    v_lshlrev_b32 v198, 16, v163
    v_and_b32 v199, 0xffff0000, v163
    v_lshlrev_b32 v200, 16, v164
    v_and_b32 v201, 0xffff0000, v164
    v_lshlrev_b32 v202, 16, v165
    v_and_b32 v203, 0xffff0000, v165
    v_lshlrev_b32 v204, 16, v166
    v_and_b32 v205, 0xffff0000, v166
    v_lshlrev_b32 v206, 16, v167
    v_and_b32 v207, 0xffff0000, v167
    v_pk_mul_f32 v[192:193], v[192:193], v[170:171] op_sel:[0,1] op_sel_hi:[1,1]
    v_pk_mul_f32 v[194:195], v[194:195], v[170:171] op_sel:[0,1] op_sel_hi:[1,1]
    v_pk_mul_f32 v[196:197], v[196:197], v[170:171] op_sel:[0,1] op_sel_hi:[1,1]
    v_pk_mul_f32 v[198:199], v[198:199], v[170:171] op_sel:[0,1] op_sel_hi:[1,1]
    v_pk_mul_f32 v[200:201], v[200:201], v[170:171] op_sel:[0,1] op_sel_hi:[1,1]
    v_pk_mul_f32 v[202:203], v[202:203], v[170:171] op_sel:[0,1] op_sel_hi:[1,1]
    v_pk_mul_f32 v[204:205], v[204:205], v[170:171] op_sel:[0,1] op_sel_hi:[1,1]
    v_pk_mul_f32 v[206:207], v[206:207], v[170:171] op_sel:[0,1] op_sel_hi:[1,1]
    v_cvt_pk_bf16_f32 v160, v192, v193
    v_cvt_pk_bf16_f32 v161, v194, v195
    v_cvt_pk_bf16_f32 v162, v196, v197
    v_cvt_pk_bf16_f32 v163, v198, v199
    v_cvt_pk_bf16_f32 v164, v200, v201
    v_cvt_pk_bf16_f32 v165, v202, v203
    v_cvt_pk_bf16_f32 v166, v204, v205
    v_cvt_pk_bf16_f32 v167, v206, v207
    ds_write_b128 v174, v[160:163]
    ds_write_b128 v175, v[164:167]
    s_mov_b32 exec_lo, 0x1ffff
    s_mov_b32 exec_hi, 0x1ffff
    buffer_store_dwordx4 v[184:187], v156, s[40:43], s88 offen offset:0 sc1
    buffer_store_dwordx4 v[184:187], v156, s[40:43], s88 offen offset:544 sc1
    s_mov_b64 exec, 15
    buffer_store_dwordx4 v[184:187], v157, s[40:43], s87 offen sc1
    s_mov_b64 exec, 14
    buffer_store_dword v184, v248, s[40:43], 0 offen sc1
    s_mov_b64 exec, -1
    s_waitcnt lgkmcnt(0)
    s_barrier
    ds_read_b64_tr_b16 v[200:201], v176
    ds_read_b64_tr_b16 v[202:203], v176 offset:4096
    ds_read_b64_tr_b16 v[204:205], v177
    ds_read_b64_tr_b16 v[206:207], v177 offset:4096
    ds_read_b64_tr_b16 v[208:209], v180 offset:0
    ds_read_b64_tr_b16 v[210:211], v180 offset:256
    ds_read_b64_tr_b16 v[212:213], v180 offset:512
    ds_read_b64_tr_b16 v[214:215], v180 offset:768
    ds_read_b128 v[72:75], v128 offset:0
    ds_read_b64_tr_b16 v[76:77], v134 offset:0
    ds_read_b64_tr_b16 v[78:79], v134 offset:512
    ds_read_b64_tr_b16 v[80:81], v134 offset:1024
    ds_read_b64_tr_b16 v[82:83], v134 offset:1536
    ds_read_b128 v[104:107], v132 offset:0
    s_waitcnt lgkmcnt(3)
    buffer_store_dwordx4 v[200:203], v179, s[40:43], s81 offen sc1
    buffer_store_dwordx4 v[204:207], v179, s[40:43], s82 offen sc1
    v_mfma_f32_32x32x16_bf16 v[16:31], v[76:79], v[72:75], 0
    ds_read_b128 v[88:91], v129 offset:0
    ds_read_b64_tr_b16 v[92:93], v134 offset:4096
    ds_read_b64_tr_b16 v[94:95], v134 offset:4608
    v_xor_b32 v208, v208, v181
    s_waitcnt lgkmcnt(4)
    v_mfma_f32_32x32x16_bf16 v[32:47], v[80:83], v[72:75], 0
    ds_read_b64_tr_b16 v[96:97], v134 offset:5120
    ds_read_b64_tr_b16 v[98:99], v134 offset:5632
    ds_read_b64_tr_b16 v[112:113], v136 offset:0
    v_xor_b32 v209, v209, v181
    s_waitcnt lgkmcnt(6)
    v_mfma_f32_16x16x32_bf16 v[60:63], v[68:71], v[104:107], 0
    ds_read_b64_tr_b16 v[114:115], v136 offset:512
    ds_read_b64_tr_b16 v[116:117], v136 offset:1024
    v_xor_b32 v210, v210, v181
    v_mfma_f32_16x16x32_bf16 v[64:67], v[104:107], v[104:107], 0
    ds_read_b64_tr_b16 v[118:119], v136 offset:1536
    v_xor_b32 v211, v211, v181
    s_waitcnt lgkmcnt(6)
    v_mfma_f32_32x32x16_bf16 v[16:31], v[92:95], v[88:91], v[16:31]
    ds_read_b128 v[72:75], v130 offset:0
    ds_read_b64_tr_b16 v[76:77], v134 offset:8192
    ds_read_b64_tr_b16 v[78:79], v134 offset:8704
    v_xor_b32 v212, v212, v181
    s_waitcnt lgkmcnt(7)
    v_mfma_f32_32x32x16_bf16 v[32:47], v[96:99], v[88:91], v[32:47]
    ds_read_b64_tr_b16 v[80:81], v134 offset:9216
    ds_read_b64_tr_b16 v[82:83], v134 offset:9728
    ds_read_b128 v[104:107], v133 offset:0
    v_xor_b32 v213, v213, v181
    s_waitcnt lgkmcnt(8)
    v_mfma_f32_16x16x32_bf16 v[52:55], v[112:115], v[68:71], 0
    v_xor_b32 v214, v214, v181
    s_waitcnt lgkmcnt(6)
    v_mfma_f32_16x16x32_bf16 v[56:59], v[116:119], v[68:71], 0
    v_xor_b32 v215, v215, v181
    s_waitcnt lgkmcnt(3)
    v_mfma_f32_32x32x16_bf16 v[16:31], v[76:79], v[72:75], v[16:31]
    ds_read_b128 v[88:91], v131 offset:0
    ds_read_b64_tr_b16 v[92:93], v134 offset:12288
    ds_read_b64_tr_b16 v[94:95], v134 offset:12800
    s_and_b32 s64, s60, 1
    s_waitcnt lgkmcnt(4)
    v_mfma_f32_32x32x16_bf16 v[32:47], v[80:83], v[72:75], v[32:47]
    ds_read_b64_tr_b16 v[96:97], v134 offset:13312
    ds_read_b64_tr_b16 v[98:99], v134 offset:13824
    ds_read_b64_tr_b16 v[112:113], v136 offset:8192
    s_lshr_b32 s65, s60, 1
    s_waitcnt lgkmcnt(6)
    v_mfma_f32_16x16x32_bf16 v[60:63], v[68:71], v[104:107], v[60:63]
    ds_read_b64_tr_b16 v[114:115], v136 offset:8704
    ds_read_b64_tr_b16 v[116:117], v136 offset:9216
    s_lshl_b32 s66, s64, 8
    v_mfma_f32_16x16x32_bf16 v[64:67], v[104:107], v[104:107], v[64:67]
    ds_read_b64_tr_b16 v[118:119], v136 offset:9728
    s_add_u32 s66, s66, 156672
    s_waitcnt lgkmcnt(6)
    v_mfma_f32_32x32x16_bf16 v[16:31], v[92:95], v[88:91], v[16:31]
    s_waitcnt lgkmcnt(0)
    s_barrier
    ds_read_b128 v[72:75], v128 offset:8192
    ds_read_b64_tr_b16 v[76:77], v134 offset:16384
    ds_read_b64_tr_b16 v[78:79], v134 offset:16896
    v_lshlrev_b32 v139, 3, v145
    v_mfma_f32_32x32x16_bf16 v[32:47], v[96:99], v[88:91], v[32:47]
    ds_read_b64_tr_b16 v[80:81], v134 offset:17408
    ds_read_b64_tr_b16 v[82:83], v134 offset:17920
    ds_read_b128 v[104:107], v132 offset:8192
    v_add_u32 v139, s66, v139
    v_mfma_f32_16x16x32_bf16 v[52:55], v[112:115], v[68:71], v[52:55]
    s_lshl_b32 s66, s65, 7
    v_mfma_f32_16x16x32_bf16 v[56:59], v[116:119], v[68:71], v[56:59]
    s_add_u32 s66, s66, 155648
    s_waitcnt lgkmcnt(3)
    v_mfma_f32_32x32x16_bf16 v[16:31], v[76:79], v[72:75], v[16:31]
    ds_read_b128 v[88:91], v129 offset:8192
    ds_read_b64_tr_b16 v[92:93], v134 offset:20480
    ds_read_b64_tr_b16 v[94:95], v134 offset:20992
    v_lshlrev_b32 v138, 4, v146
    s_waitcnt lgkmcnt(4)
    v_mfma_f32_32x32x16_bf16 v[32:47], v[80:83], v[72:75], v[32:47]
    ds_read_b64_tr_b16 v[96:97], v134 offset:21504
    ds_read_b64_tr_b16 v[98:99], v134 offset:22016
    ds_read_b64_tr_b16 v[112:113], v136 offset:16384
    v_add_u32 v138, s66, v138
    s_waitcnt lgkmcnt(6)
    v_mfma_f32_16x16x32_bf16 v[60:63], v[68:71], v[104:107], v[60:63]
    ds_read_b64_tr_b16 v[114:115], v136 offset:16896
    ds_read_b64_tr_b16 v[116:117], v136 offset:17408
    s_lshl_b32 s66, s65, 12
    v_mfma_f32_16x16x32_bf16 v[64:67], v[104:107], v[104:107], v[64:67]
    ds_read_b64_tr_b16 v[118:119], v136 offset:17920
    s_lshl_b32 s69, s64, 10
    s_waitcnt lgkmcnt(6)
    v_mfma_f32_32x32x16_bf16 v[16:31], v[92:95], v[88:91], v[16:31]
    ds_read_b128 v[72:75], v130 offset:8192
    ds_read_b64_tr_b16 v[76:77], v134 offset:24576
    ds_read_b64_tr_b16 v[78:79], v134 offset:25088
    s_add_u32 s66, s66, s69
    s_waitcnt lgkmcnt(7)
    v_mfma_f32_32x32x16_bf16 v[32:47], v[96:99], v[88:91], v[32:47]
    ds_read_b64_tr_b16 v[80:81], v134 offset:25600
    ds_read_b64_tr_b16 v[82:83], v134 offset:26112
    ds_read_b128 v[104:107], v133 offset:8192
    s_add_u32 s66, s66, 147456
    s_waitcnt lgkmcnt(8)
    v_mfma_f32_16x16x32_bf16 v[52:55], v[112:115], v[68:71], v[52:55]
    v_xor_b32 v126, v149, v146
    s_waitcnt lgkmcnt(6)
    v_mfma_f32_16x16x32_bf16 v[56:59], v[116:119], v[68:71], v[56:59]
    v_lshlrev_b32 v126, 3, v126
    s_waitcnt lgkmcnt(3)
    v_mfma_f32_32x32x16_bf16 v[16:31], v[76:79], v[72:75], v[16:31]
    ds_read_b128 v[88:91], v131 offset:8192
    ds_read_b64_tr_b16 v[92:93], v134 offset:28672
    ds_read_b64_tr_b16 v[94:95], v134 offset:29184
    v_lshl_add_u32 v140, v145, 5, v126
    s_waitcnt lgkmcnt(4)
    v_mfma_f32_32x32x16_bf16 v[32:47], v[80:83], v[72:75], v[32:47]
    ds_read_b64_tr_b16 v[96:97], v134 offset:29696
    ds_read_b64_tr_b16 v[98:99], v134 offset:30208
    ds_read_b64_tr_b16 v[112:113], v136 offset:24576
    v_add_u32 v140, s66, v140
    s_waitcnt lgkmcnt(6)
    v_mfma_f32_16x16x32_bf16 v[60:63], v[68:71], v[104:107], v[60:63]
    ds_read_b64_tr_b16 v[114:115], v136 offset:25088
    ds_read_b64_tr_b16 v[116:117], v136 offset:25600
    v_xor_b32 v141, 16, v140
    v_mfma_f32_16x16x32_bf16 v[64:67], v[104:107], v[104:107], v[64:67]
    ds_read_b64_tr_b16 v[118:119], v136 offset:26112
    s_lshl_b32 s66, s65, 13
    s_waitcnt lgkmcnt(6)
    v_mfma_f32_32x32x16_bf16 v[16:31], v[92:95], v[88:91], v[16:31]
    s_waitcnt lgkmcnt(0)
    s_barrier
    ds_read_b128 v[72:75], v128 offset:16384
    ds_read_b64_tr_b16 v[76:77], v134 offset:32768
    ds_read_b64_tr_b16 v[78:79], v134 offset:33280
    s_lshl_b32 s69, s64, 11
    v_mfma_f32_32x32x16_bf16 v[32:47], v[96:99], v[88:91], v[32:47]
    ds_read_b64_tr_b16 v[80:81], v134 offset:33792
    ds_read_b64_tr_b16 v[82:83], v134 offset:34304
    ds_read_b128 v[104:107], v132 offset:16384
    s_add_u32 s66, s66, s69
    v_mfma_f32_16x16x32_bf16 v[52:55], v[112:115], v[68:71], v[52:55]
    s_add_u32 s66, s66, 131072
    v_mfma_f32_16x16x32_bf16 v[56:59], v[116:119], v[68:71], v[56:59]
    v_bfe_u32 v126, v144, 1, 3
    s_waitcnt lgkmcnt(3)
    v_mfma_f32_32x32x16_bf16 v[16:31], v[76:79], v[72:75], v[16:31]
    ds_read_b128 v[88:91], v129 offset:16384
    ds_read_b64_tr_b16 v[92:93], v134 offset:36864
    ds_read_b64_tr_b16 v[94:95], v134 offset:37376
    v_xor_b32 v126, v126, v146
    s_waitcnt lgkmcnt(4)
    v_mfma_f32_32x32x16_bf16 v[32:47], v[80:83], v[72:75], v[32:47]
    ds_read_b64_tr_b16 v[96:97], v134 offset:37888
    ds_read_b64_tr_b16 v[98:99], v134 offset:38400
    ds_read_b64_tr_b16 v[112:113], v136 offset:32768
    v_lshlrev_b32 v126, 3, v126
    s_waitcnt lgkmcnt(6)
    v_mfma_f32_16x16x32_bf16 v[60:63], v[68:71], v[104:107], v[60:63]
    ds_read_b64_tr_b16 v[114:115], v136 offset:33280
    ds_read_b64_tr_b16 v[116:117], v136 offset:33792
    v_lshl_add_u32 v142, v145, 6, v126
    v_mfma_f32_16x16x32_bf16 v[64:67], v[104:107], v[104:107], v[64:67]
    ds_read_b64_tr_b16 v[118:119], v136 offset:34304
    v_add_u32 v142, s66, v142
    s_waitcnt lgkmcnt(6)
    v_mfma_f32_32x32x16_bf16 v[16:31], v[92:95], v[88:91], v[16:31]
    ds_read_b128 v[72:75], v130 offset:16384
    ds_read_b64_tr_b16 v[76:77], v134 offset:40960
    ds_read_b64_tr_b16 v[78:79], v134 offset:41472
    v_xor_b32 v143, 16, v142
    s_waitcnt lgkmcnt(7)
    v_mfma_f32_32x32x16_bf16 v[32:47], v[96:99], v[88:91], v[32:47]
    ds_read_b64_tr_b16 v[80:81], v134 offset:41984
    ds_read_b64_tr_b16 v[82:83], v134 offset:42496
    ds_read_b128 v[104:107], v133 offset:16384
    v_xor_b32 v120, 32, v142
    s_waitcnt lgkmcnt(8)
    v_mfma_f32_16x16x32_bf16 v[52:55], v[112:115], v[68:71], v[52:55]
    v_xor_b32 v121, 48, v142
    s_waitcnt lgkmcnt(6)
    v_mfma_f32_16x16x32_bf16 v[56:59], v[116:119], v[68:71], v[56:59]
    v_lshl_add_u32 v126, v146, 3, v149
    s_waitcnt lgkmcnt(3)
    v_mfma_f32_32x32x16_bf16 v[16:31], v[76:79], v[72:75], v[16:31]
    ds_read_b128 v[88:91], v131 offset:16384
    ds_read_b64_tr_b16 v[92:93], v134 offset:45056
    ds_read_b64_tr_b16 v[94:95], v134 offset:45568
    v_bfe_u32 v122, v144, 4, 1
    s_waitcnt lgkmcnt(4)
    v_mfma_f32_32x32x16_bf16 v[32:47], v[80:83], v[72:75], v[32:47]
    ds_read_b64_tr_b16 v[96:97], v134 offset:46080
    ds_read_b64_tr_b16 v[98:99], v134 offset:46592
    ds_read_b64_tr_b16 v[112:113], v136 offset:40960
    v_lshl_add_u32 v122, v122, 2, v150
    s_waitcnt lgkmcnt(6)
    v_mfma_f32_16x16x32_bf16 v[60:63], v[68:71], v[104:107], v[60:63]
    ds_read_b64_tr_b16 v[114:115], v136 offset:41472
    ds_read_b64_tr_b16 v[116:117], v136 offset:41984
    v_lshrrev_b32 v123, 1, v126
    v_mfma_f32_16x16x32_bf16 v[64:67], v[104:107], v[104:107], v[64:67]
    ds_read_b64_tr_b16 v[118:119], v136 offset:42496
    v_xor_b32 v122, v122, v123
    s_waitcnt lgkmcnt(6)
    v_mfma_f32_32x32x16_bf16 v[16:31], v[92:95], v[88:91], v[16:31]
    s_waitcnt lgkmcnt(0)
    s_waitcnt vmcnt(0)
    s_lshl_b32 s86, s72, 5
    s_barrier
    s_cmp_lg_u32 s60, 0
    s_nop 6
    s_cbranch_scc1 L_PUB1
    v_mov_b32 v158, 1
    v_mov_b32 v159, 0
    s_mov_b64 exec, 1
    buffer_atomic_add v158, v159, s[52:55], s86 offen sc1
    s_mov_b64 exec, -1
L_PUB1:
    ds_read_b128 v[72:75], v128 offset:24576
    ds_read_b64_tr_b16 v[76:77], v134 offset:49152
    ds_read_b64_tr_b16 v[78:79], v134 offset:49664
    v_lshlrev_b32 v122, 3, v122
    v_mfma_f32_32x32x16_bf16 v[32:47], v[96:99], v[88:91], v[32:47]
    ds_read_b64_tr_b16 v[80:81], v134 offset:50176
    ds_read_b64_tr_b16 v[82:83], v134 offset:50688
    ds_read_b128 v[104:107], v132 offset:24576
    v_lshl_add_u32 v122, v126, 6, v122
    v_mfma_f32_16x16x32_bf16 v[52:55], v[112:115], v[68:71], v[52:55]
    s_lshl_b32 s66, s60, 12
    v_mfma_f32_16x16x32_bf16 v[56:59], v[116:119], v[68:71], v[56:59]
    s_add_u32 s66, s66, 131072
    s_waitcnt lgkmcnt(3)
    v_mfma_f32_32x32x16_bf16 v[16:31], v[76:79], v[72:75], v[16:31]
    ds_read_b128 v[88:91], v129 offset:24576
    ds_read_b64_tr_b16 v[92:93], v134 offset:53248
    ds_read_b64_tr_b16 v[94:95], v134 offset:53760
    v_add_u32 v122, s66, v122
    s_waitcnt lgkmcnt(4)
    v_mfma_f32_32x32x16_bf16 v[32:47], v[80:83], v[72:75], v[32:47]
    ds_read_b64_tr_b16 v[96:97], v134 offset:54272
    ds_read_b64_tr_b16 v[98:99], v134 offset:54784
    ds_read_b64_tr_b16 v[112:113], v136 offset:49152
    v_xor_b32 v123, 16, v122
    s_waitcnt lgkmcnt(6)
    v_mfma_f32_16x16x32_bf16 v[60:63], v[68:71], v[104:107], v[60:63]
    ds_read_b64_tr_b16 v[114:115], v136 offset:49664
    ds_read_b64_tr_b16 v[116:117], v136 offset:50176
    v_add_u32 v123, 256, v123
    v_mfma_f32_16x16x32_bf16 v[64:67], v[104:107], v[104:107], v[64:67]
    ds_read_b64_tr_b16 v[118:119], v136 offset:50688
    v_lshrrev_b32 v124, 2, v126
    s_waitcnt lgkmcnt(6)
    v_mfma_f32_32x32x16_bf16 v[16:31], v[92:95], v[88:91], v[16:31]
    ds_read_b128 v[72:75], v130 offset:24576
    ds_read_b64_tr_b16 v[76:77], v134 offset:57344
    ds_read_b64_tr_b16 v[78:79], v134 offset:57856
    v_xor_b32 v124, v124, v150
    s_waitcnt lgkmcnt(7)
    v_mfma_f32_32x32x16_bf16 v[32:47], v[96:99], v[88:91], v[32:47]
    ds_read_b64_tr_b16 v[80:81], v134 offset:58368
    ds_read_b64_tr_b16 v[82:83], v134 offset:58880
    ds_read_b128 v[104:107], v133 offset:24576
    v_lshlrev_b32 v124, 3, v124
    s_waitcnt lgkmcnt(8)
    v_mfma_f32_16x16x32_bf16 v[52:55], v[112:115], v[68:71], v[52:55]
    v_lshl_add_u32 v124, v126, 5, v124
    s_waitcnt lgkmcnt(6)
    v_mfma_f32_16x16x32_bf16 v[56:59], v[116:119], v[68:71], v[56:59]
    s_lshl_b32 s66, s60, 11
    s_waitcnt lgkmcnt(3)
    v_mfma_f32_32x32x16_bf16 v[16:31], v[76:79], v[72:75], v[16:31]
    ds_read_b128 v[88:91], v131 offset:24576
    ds_read_b64_tr_b16 v[92:93], v134 offset:61440
    ds_read_b64_tr_b16 v[94:95], v134 offset:61952
    s_add_u32 s66, s66, 147456
    s_waitcnt lgkmcnt(4)
    v_mfma_f32_32x32x16_bf16 v[32:47], v[80:83], v[72:75], v[32:47]
    ds_read_b64_tr_b16 v[96:97], v134 offset:62464
    ds_read_b64_tr_b16 v[98:99], v134 offset:62976
    ds_read_b64_tr_b16 v[112:113], v136 offset:57344
    v_add_u32 v124, s66, v124
    s_waitcnt lgkmcnt(6)
    v_mfma_f32_16x16x32_bf16 v[60:63], v[68:71], v[104:107], v[60:63]
    ds_read_b64_tr_b16 v[114:115], v136 offset:57856
    ds_read_b64_tr_b16 v[116:117], v136 offset:58368
    v_xor_b32 v125, 8, v124
    v_mfma_f32_16x16x32_bf16 v[64:67], v[104:107], v[104:107], v[64:67]
    ds_read_b64_tr_b16 v[118:119], v136 offset:58880
    v_add_u32 v125, 128, v125
    s_waitcnt lgkmcnt(6)
    v_mfma_f32_32x32x16_bf16 v[16:31], v[92:95], v[88:91], v[16:31]
    s_waitcnt lgkmcnt(0)
    s_barrier
    ds_read_b128 v[72:75], v128 offset:32768
    ds_read_b64_tr_b16 v[76:77], v134 offset:0
    ds_read_b64_tr_b16 v[78:79], v134 offset:512
    s_lshr_b32 s76, s60, 1
    v_mfma_f32_32x32x16_bf16 v[32:47], v[96:99], v[88:91], v[32:47]
    ds_read_b64_tr_b16 v[80:81], v134 offset:1024
    ds_read_b64_tr_b16 v[82:83], v134 offset:1536
    ds_read_b128 v[104:107], v132 offset:32768
    s_mul_i32 s76, s76, 6
    v_mfma_f32_16x16x32_bf16 v[52:55], v[112:115], v[68:71], v[52:55]
    v_lshl_add_u32 v228, v148, 3, v149
    v_mfma_f32_16x16x32_bf16 v[56:59], v[116:119], v[68:71], v[56:59]
    v_mul_u32_u24 v228, 192, v228
    s_waitcnt lgkmcnt(3)
    v_mfma_f32_32x32x16_bf16 v[16:31], v[76:79], v[72:75], v[16:31]
    ds_read_b128 v[88:91], v129 offset:32768
    ds_read_b64_tr_b16 v[92:93], v134 offset:4096
    ds_read_b64_tr_b16 v[94:95], v134 offset:4608
    v_and_b32 v229, 1, v144
    s_waitcnt lgkmcnt(4)
    v_mfma_f32_32x32x16_bf16 v[32:47], v[80:83], v[72:75], v[32:47]
    ds_read_b64_tr_b16 v[96:97], v134 offset:5120
    ds_read_b64_tr_b16 v[98:99], v134 offset:5632
    ds_read_b64_tr_b16 v[112:113], v136 offset:0
    v_lshl_add_u32 v228, v229, 3, v228
    s_waitcnt lgkmcnt(6)
    v_mfma_f32_16x16x32_bf16 v[60:63], v[68:71], v[104:107], v[60:63]
    ds_read_b64_tr_b16 v[114:115], v136 offset:512
    ds_read_b64_tr_b16 v[116:117], v136 offset:1024
    v_bfe_u32 v229, v144, 1, 1
    v_mfma_f32_16x16x32_bf16 v[64:67], v[104:107], v[104:107], v[64:67]
    ds_read_b64_tr_b16 v[118:119], v136 offset:1536
    v_add_u32 v229, s76, v229
    s_waitcnt lgkmcnt(6)
    v_mfma_f32_32x32x16_bf16 v[16:31], v[92:95], v[88:91], v[16:31]
    ds_read_b128 v[72:75], v130 offset:32768
    ds_read_b64_tr_b16 v[76:77], v134 offset:8192
    ds_read_b64_tr_b16 v[78:79], v134 offset:8704
    v_bfe_u32 v230, v144, 4, 1
    s_waitcnt lgkmcnt(7)
    v_mfma_f32_32x32x16_bf16 v[32:47], v[96:99], v[88:91], v[32:47]
    ds_read_b64_tr_b16 v[80:81], v134 offset:9216
    ds_read_b64_tr_b16 v[82:83], v134 offset:9728
    ds_read_b128 v[104:107], v133 offset:32768
    v_lshlrev_b32 v230, 1, v230
    s_waitcnt lgkmcnt(8)
    v_mfma_f32_16x16x32_bf16 v[52:55], v[112:115], v[68:71], v[52:55]
    v_add_u32 v216, 0, v229
    s_waitcnt lgkmcnt(6)
    v_mfma_f32_16x16x32_bf16 v[56:59], v[116:119], v[68:71], v[56:59]
    v_xor_b32 v216, v216, v230
    s_waitcnt lgkmcnt(3)
    v_mfma_f32_32x32x16_bf16 v[16:31], v[76:79], v[72:75], v[16:31]
    ds_read_b128 v[88:91], v131 offset:32768
    ds_read_b64_tr_b16 v[92:93], v134 offset:12288
    ds_read_b64_tr_b16 v[94:95], v134 offset:12800
    v_lshl_add_u32 v216, v216, 4, v228
    s_waitcnt lgkmcnt(4)
    v_mfma_f32_32x32x16_bf16 v[32:47], v[80:83], v[72:75], v[32:47]
    ds_read_b64_tr_b16 v[96:97], v134 offset:13312
    ds_read_b64_tr_b16 v[98:99], v134 offset:13824
    ds_read_b64_tr_b16 v[112:113], v136 offset:8192
    v_add_u32 v219, 65536, v216
    s_waitcnt lgkmcnt(6)
    v_mfma_f32_16x16x32_bf16 v[60:63], v[68:71], v[104:107], v[60:63]
    ds_read_b64_tr_b16 v[114:115], v136 offset:8704
    ds_read_b64_tr_b16 v[116:117], v136 offset:9216
    v_add_u32 v217, 2, v229
    v_mfma_f32_16x16x32_bf16 v[64:67], v[104:107], v[104:107], v[64:67]
    ds_read_b64_tr_b16 v[118:119], v136 offset:9728
    v_xor_b32 v217, v217, v230
    s_waitcnt lgkmcnt(6)
    v_mfma_f32_32x32x16_bf16 v[16:31], v[92:95], v[88:91], v[16:31]
    s_waitcnt lgkmcnt(0)
    s_barrier
    ds_read_b128 v[72:75], v128 offset:40960
    ds_read_b64_tr_b16 v[76:77], v134 offset:16384
    ds_read_b64_tr_b16 v[78:79], v134 offset:16896
    v_lshl_add_u32 v217, v217, 4, v228
    v_mfma_f32_32x32x16_bf16 v[32:47], v[96:99], v[88:91], v[32:47]
    ds_read_b64_tr_b16 v[80:81], v134 offset:17408
    ds_read_b64_tr_b16 v[82:83], v134 offset:17920
    ds_read_b128 v[104:107], v132 offset:40960
    v_add_u32 v220, 65536, v217
    v_mfma_f32_16x16x32_bf16 v[52:55], v[112:115], v[68:71], v[52:55]
    v_add_u32 v218, 4, v229
    v_mfma_f32_16x16x32_bf16 v[56:59], v[116:119], v[68:71], v[56:59]
    v_xor_b32 v218, v218, v230
    s_waitcnt lgkmcnt(3)
    v_mfma_f32_32x32x16_bf16 v[16:31], v[76:79], v[72:75], v[16:31]
    ds_read_b128 v[88:91], v129 offset:40960
    ds_read_b64_tr_b16 v[92:93], v134 offset:20480
    ds_read_b64_tr_b16 v[94:95], v134 offset:20992
    v_lshl_add_u32 v218, v218, 4, v228
    s_waitcnt lgkmcnt(4)
    v_mfma_f32_32x32x16_bf16 v[32:47], v[80:83], v[72:75], v[32:47]
    ds_read_b64_tr_b16 v[96:97], v134 offset:21504
    ds_read_b64_tr_b16 v[98:99], v134 offset:22016
    ds_read_b64_tr_b16 v[112:113], v136 offset:16384
    v_add_u32 v221, 65536, v218
    s_waitcnt lgkmcnt(6)
    v_mfma_f32_16x16x32_bf16 v[60:63], v[68:71], v[104:107], v[60:63]
    ds_read_b64_tr_b16 v[114:115], v136 offset:16896
    ds_read_b64_tr_b16 v[116:117], v136 offset:17408
    s_and_b32 s76, s60, 1
    v_mfma_f32_16x16x32_bf16 v[64:67], v[104:107], v[104:107], v[64:67]
    ds_read_b64_tr_b16 v[118:119], v136 offset:17920
    s_lshl_b32 s76, s76, 13
    s_waitcnt lgkmcnt(6)
    v_mfma_f32_32x32x16_bf16 v[16:31], v[92:95], v[88:91], v[16:31]
    ds_read_b128 v[72:75], v130 offset:40960
    ds_read_b64_tr_b16 v[76:77], v134 offset:24576
    ds_read_b64_tr_b16 v[78:79], v134 offset:25088
    s_add_u32 s76, s76, 12288
    s_waitcnt lgkmcnt(7)
    v_mfma_f32_32x32x16_bf16 v[32:47], v[96:99], v[88:91], v[32:47]
    ds_read_b64_tr_b16 v[80:81], v134 offset:25600
    ds_read_b64_tr_b16 v[82:83], v134 offset:26112
    ds_read_b128 v[104:107], v133 offset:40960
    v_add_u32 v222, s76, v157
    s_waitcnt lgkmcnt(8)
    v_mfma_f32_16x16x32_bf16 v[52:55], v[112:115], v[68:71], v[52:55]
    v_add_u32 v223, 65536, v222
    s_waitcnt lgkmcnt(6)
    v_mfma_f32_16x16x32_bf16 v[56:59], v[116:119], v[68:71], v[56:59]
    s_lshl_b32 s76, s60, 6
    s_waitcnt lgkmcnt(3)
    v_mfma_f32_32x32x16_bf16 v[16:31], v[76:79], v[72:75], v[16:31]
    ds_read_b128 v[88:91], v131 offset:40960
    ds_read_b64_tr_b16 v[92:93], v134 offset:28672
    ds_read_b64_tr_b16 v[94:95], v134 offset:29184
    s_add_u32 s76, s76, 155648
    s_waitcnt lgkmcnt(4)
    v_mfma_f32_32x32x16_bf16 v[32:47], v[80:83], v[72:75], v[32:47]
    ds_read_b64_tr_b16 v[96:97], v134 offset:29696
    ds_read_b64_tr_b16 v[98:99], v134 offset:30208
    ds_read_b64_tr_b16 v[112:113], v136 offset:24576
    v_lshlrev_b32 v224, 4, v148
    s_waitcnt lgkmcnt(6)
    v_mfma_f32_16x16x32_bf16 v[60:63], v[68:71], v[104:107], v[60:63]
    ds_read_b64_tr_b16 v[114:115], v136 offset:25088
    ds_read_b64_tr_b16 v[116:117], v136 offset:25600
    v_add_u32 v224, s76, v224
    v_mfma_f32_16x16x32_bf16 v[64:67], v[104:107], v[104:107], v[64:67]
    ds_read_b64_tr_b16 v[118:119], v136 offset:26112
    s_lshl_b32 s76, s60, 7
    s_waitcnt lgkmcnt(6)
    v_mfma_f32_32x32x16_bf16 v[16:31], v[92:95], v[88:91], v[16:31]
    s_waitcnt lgkmcnt(0)
    s_barrier
    ds_read_b128 v[72:75], v128 offset:49152
    ds_read_b64_tr_b16 v[76:77], v134 offset:32768
    ds_read_b64_tr_b16 v[78:79], v134 offset:33280
    s_add_u32 s76, s76, 156672
    v_mfma_f32_32x32x16_bf16 v[32:47], v[96:99], v[88:91], v[32:47]
    ds_read_b64_tr_b16 v[80:81], v134 offset:33792
    ds_read_b64_tr_b16 v[82:83], v134 offset:34304
    ds_read_b128 v[104:107], v132 offset:49152
    v_lshlrev_b32 v225, 3, v147
    v_mfma_f32_16x16x32_bf16 v[52:55], v[112:115], v[68:71], v[52:55]
    v_add_u32 v225, s76, v225
    v_mfma_f32_16x16x32_bf16 v[56:59], v[116:119], v[68:71], v[56:59]
    s_waitcnt lgkmcnt(3)
    v_mfma_f32_32x32x16_bf16 v[16:31], v[76:79], v[72:75], v[16:31]
    ds_read_b128 v[88:91], v129 offset:49152
    ds_read_b64_tr_b16 v[92:93], v134 offset:36864
    ds_read_b64_tr_b16 v[94:95], v134 offset:37376
    s_waitcnt lgkmcnt(4)
    v_mfma_f32_32x32x16_bf16 v[32:47], v[80:83], v[72:75], v[32:47]
    ds_read_b64_tr_b16 v[96:97], v134 offset:37888
    ds_read_b64_tr_b16 v[98:99], v134 offset:38400
    ds_read_b64_tr_b16 v[112:113], v136 offset:32768
    s_waitcnt lgkmcnt(6)
    v_mfma_f32_16x16x32_bf16 v[60:63], v[68:71], v[104:107], v[60:63]
    ds_read_b64_tr_b16 v[114:115], v136 offset:33280
    ds_read_b64_tr_b16 v[116:117], v136 offset:33792
    v_mfma_f32_16x16x32_bf16 v[64:67], v[104:107], v[104:107], v[64:67]
    ds_read_b64_tr_b16 v[118:119], v136 offset:34304
    s_waitcnt lgkmcnt(6)
    v_mfma_f32_32x32x16_bf16 v[16:31], v[92:95], v[88:91], v[16:31]
    ds_read_b128 v[72:75], v130 offset:49152
    ds_read_b64_tr_b16 v[76:77], v134 offset:40960
    ds_read_b64_tr_b16 v[78:79], v134 offset:41472
    s_waitcnt lgkmcnt(7)
    v_mfma_f32_32x32x16_bf16 v[32:47], v[96:99], v[88:91], v[32:47]
    ds_read_b64_tr_b16 v[80:81], v134 offset:41984
    ds_read_b64_tr_b16 v[82:83], v134 offset:42496
    ds_read_b128 v[104:107], v133 offset:49152
    s_waitcnt lgkmcnt(8)
    v_mfma_f32_16x16x32_bf16 v[52:55], v[112:115], v[68:71], v[52:55]
    s_waitcnt lgkmcnt(6)
    v_mfma_f32_16x16x32_bf16 v[56:59], v[116:119], v[68:71], v[56:59]
    s_waitcnt lgkmcnt(3)
    v_mfma_f32_32x32x16_bf16 v[16:31], v[76:79], v[72:75], v[16:31]
    ds_read_b128 v[88:91], v131 offset:49152
    ds_read_b64_tr_b16 v[92:93], v134 offset:45056
    ds_read_b64_tr_b16 v[94:95], v134 offset:45568
    s_waitcnt lgkmcnt(4)
    v_mfma_f32_32x32x16_bf16 v[32:47], v[80:83], v[72:75], v[32:47]
    ds_read_b64_tr_b16 v[96:97], v134 offset:46080
    ds_read_b64_tr_b16 v[98:99], v134 offset:46592
    ds_read_b64_tr_b16 v[112:113], v136 offset:40960
    s_waitcnt lgkmcnt(6)
    v_mfma_f32_16x16x32_bf16 v[60:63], v[68:71], v[104:107], v[60:63]
    ds_read_b64_tr_b16 v[114:115], v136 offset:41472
    ds_read_b64_tr_b16 v[116:117], v136 offset:41984
    v_mfma_f32_16x16x32_bf16 v[64:67], v[104:107], v[104:107], v[64:67]
    ds_read_b64_tr_b16 v[118:119], v136 offset:42496
    s_waitcnt lgkmcnt(6)
    v_mfma_f32_32x32x16_bf16 v[16:31], v[92:95], v[88:91], v[16:31]
    s_waitcnt lgkmcnt(0)
    s_barrier
    ds_read_b128 v[72:75], v128 offset:57344
    ds_read_b64_tr_b16 v[76:77], v134 offset:49152
    ds_read_b64_tr_b16 v[78:79], v134 offset:49664
    v_mfma_f32_32x32x16_bf16 v[32:47], v[96:99], v[88:91], v[32:47]
    ds_read_b64_tr_b16 v[80:81], v134 offset:50176
    ds_read_b64_tr_b16 v[82:83], v134 offset:50688
    ds_read_b128 v[104:107], v132 offset:57344
    v_mfma_f32_16x16x32_bf16 v[52:55], v[112:115], v[68:71], v[52:55]
    v_mfma_f32_16x16x32_bf16 v[56:59], v[116:119], v[68:71], v[56:59]
    s_waitcnt lgkmcnt(3)
    v_mfma_f32_32x32x16_bf16 v[16:31], v[76:79], v[72:75], v[16:31]
    ds_read_b128 v[88:91], v129 offset:57344
    ds_read_b64_tr_b16 v[92:93], v134 offset:53248
    ds_read_b64_tr_b16 v[94:95], v134 offset:53760
    s_waitcnt lgkmcnt(4)
    v_mfma_f32_32x32x16_bf16 v[32:47], v[80:83], v[72:75], v[32:47]
    ds_read_b64_tr_b16 v[96:97], v134 offset:54272
    ds_read_b64_tr_b16 v[98:99], v134 offset:54784
    ds_read_b64_tr_b16 v[112:113], v136 offset:49152
    s_waitcnt lgkmcnt(6)
    v_mfma_f32_16x16x32_bf16 v[60:63], v[68:71], v[104:107], v[60:63]
    ds_read_b64_tr_b16 v[114:115], v136 offset:49664
    ds_read_b64_tr_b16 v[116:117], v136 offset:50176
    v_mfma_f32_16x16x32_bf16 v[64:67], v[104:107], v[104:107], v[64:67]
    ds_read_b64_tr_b16 v[118:119], v136 offset:50688
    s_waitcnt lgkmcnt(6)
    v_mfma_f32_32x32x16_bf16 v[16:31], v[92:95], v[88:91], v[16:31]
    ds_read_b128 v[72:75], v130 offset:57344
    ds_read_b64_tr_b16 v[76:77], v134 offset:57344
    ds_read_b64_tr_b16 v[78:79], v134 offset:57856
    s_waitcnt lgkmcnt(7)
    v_mfma_f32_32x32x16_bf16 v[32:47], v[96:99], v[88:91], v[32:47]
    ds_read_b64_tr_b16 v[80:81], v134 offset:58368
    ds_read_b64_tr_b16 v[82:83], v134 offset:58880
    ds_read_b128 v[104:107], v133 offset:57344
    s_waitcnt lgkmcnt(8)
    v_mfma_f32_16x16x32_bf16 v[52:55], v[112:115], v[68:71], v[52:55]
    s_waitcnt lgkmcnt(6)
    v_mfma_f32_16x16x32_bf16 v[56:59], v[116:119], v[68:71], v[56:59]
    s_waitcnt lgkmcnt(3)
    v_mfma_f32_32x32x16_bf16 v[16:31], v[76:79], v[72:75], v[16:31]
    ds_read_b128 v[88:91], v131 offset:57344
    ds_read_b64_tr_b16 v[92:93], v134 offset:61440
    ds_read_b64_tr_b16 v[94:95], v134 offset:61952
    s_waitcnt lgkmcnt(4)
    v_mfma_f32_32x32x16_bf16 v[32:47], v[80:83], v[72:75], v[32:47]
    ds_read_b64_tr_b16 v[96:97], v134 offset:62464
    ds_read_b64_tr_b16 v[98:99], v134 offset:62976
    ds_read_b64_tr_b16 v[112:113], v136 offset:57344
    s_waitcnt lgkmcnt(6)
    v_mfma_f32_16x16x32_bf16 v[60:63], v[68:71], v[104:107], v[60:63]
    ds_read_b64_tr_b16 v[114:115], v136 offset:57856
    ds_read_b64_tr_b16 v[116:117], v136 offset:58368
    v_mfma_f32_16x16x32_bf16 v[64:67], v[104:107], v[104:107], v[64:67]
    ds_read_b64_tr_b16 v[118:119], v136 offset:58880
    s_waitcnt lgkmcnt(6)
    v_mfma_f32_32x32x16_bf16 v[16:31], v[92:95], v[88:91], v[16:31]
    s_waitcnt lgkmcnt(4)
    v_mfma_f32_32x32x16_bf16 v[32:47], v[96:99], v[88:91], v[32:47]
    s_waitcnt lgkmcnt(2)
    v_mfma_f32_16x16x32_bf16 v[52:55], v[112:115], v[68:71], v[52:55]
    s_waitcnt lgkmcnt(0)
    v_mfma_f32_16x16x32_bf16 v[56:59], v[116:119], v[68:71], v[56:59]
    v_cmp_eq_u32 vcc, 1, v150
    s_nop 1
    v_cndmask_b32 v227, v64, v65, vcc
    v_cmp_eq_u32 vcc, 2, v150
    s_nop 1
    v_cndmask_b32 v227, v227, v66, vcc
    v_cmp_eq_u32 vcc, 3, v150
    s_nop 1
    v_cndmask_b32 v227, v227, v67, vcc
    v_mov_b32 v226, v60
    v_cmp_eq_u32 vcc, v149, v148
    s_nop 0
    s_and_saveexec_b64 s[84:85], vcc
    ds_write_b64 v225, v[226:227]
    s_mov_b64 exec, s[84:85]
    s_mov_b32 exec_lo, 0x10001
    s_mov_b32 exec_hi, 0x10001
    ds_write_b128 v224, v[52:55] offset:256
    ds_write_b128 v224, v[56:59] offset:512
    s_mov_b64 exec, -1
    s_waitcnt lgkmcnt(0)
    s_barrier
    ds_read_b64 v[226:227], v139
    ds_read_b128 v[176:179], v138 offset:256
    ds_read_b128 v[180:183], v138 offset:288
    ds_read_b128 v[184:187], v138 offset:320
    ds_read_b128 v[188:191], v138 offset:352
    ds_read_b128 v[192:195], v138 offset:512
    ds_read_b128 v[196:199], v138 offset:544
    ds_read_b128 v[200:203], v138 offset:576
    ds_read_b128 v[204:207], v138 offset:608
    s_waitcnt lgkmcnt(8)
    v_mul_f32 v226, 0x3b000000, v226
    v_mul_f32 v227, 0x3b000000, v227
    v_fma_f32 v227, -v226, v226, v227
    v_max_f32 v227, 0, v227
    v_cvt_pk_bf16_f32 v228, v226, v226
    v_and_b32 v228, 0xffff0000, v228
    v_cvt_pk_bf16_f32 v230, v227, v227
    v_and_b32 v230, 0xffff0000, v230
    v_add_f32 v230, 0x3727c5ac, v230
    v_cvt_pk_bf16_f32 v230, v230, v230
    v_and_b32 v230, 0xffff0000, v230
    v_sqrt_f32 v230, v230
    s_nop 0
    v_cvt_pk_bf16_f32 v230, v230, v230
    v_and_b32 v230, 0xffff0000, v230
    v_rcp_f32 v229, v230
    s_waitcnt lgkmcnt(4)
    v_pk_fma_f32 v[16:17], v[176:177], v[228:229], v[16:17] op_sel_hi:[1,0,1] neg_lo:[0,1,0] neg_hi:[0,1,0]
    v_pk_fma_f32 v[18:19], v[178:179], v[228:229], v[18:19] op_sel_hi:[1,0,1] neg_lo:[0,1,0] neg_hi:[0,1,0]
    v_pk_fma_f32 v[20:21], v[180:181], v[228:229], v[20:21] op_sel_hi:[1,0,1] neg_lo:[0,1,0] neg_hi:[0,1,0]
    v_pk_fma_f32 v[22:23], v[182:183], v[228:229], v[22:23] op_sel_hi:[1,0,1] neg_lo:[0,1,0] neg_hi:[0,1,0]
    v_pk_fma_f32 v[24:25], v[184:185], v[228:229], v[24:25] op_sel_hi:[1,0,1] neg_lo:[0,1,0] neg_hi:[0,1,0]
    v_pk_fma_f32 v[26:27], v[186:187], v[228:229], v[26:27] op_sel_hi:[1,0,1] neg_lo:[0,1,0] neg_hi:[0,1,0]
    v_pk_fma_f32 v[28:29], v[188:189], v[228:229], v[28:29] op_sel_hi:[1,0,1] neg_lo:[0,1,0] neg_hi:[0,1,0]
    v_pk_fma_f32 v[30:31], v[190:191], v[228:229], v[30:31] op_sel_hi:[1,0,1] neg_lo:[0,1,0] neg_hi:[0,1,0]
    v_pk_mul_f32 v[16:17], v[16:17], v[228:229] op_sel:[0,1] op_sel_hi:[1,1]
    v_pk_mul_f32 v[18:19], v[18:19], v[228:229] op_sel:[0,1] op_sel_hi:[1,1]
    v_pk_mul_f32 v[20:21], v[20:21], v[228:229] op_sel:[0,1] op_sel_hi:[1,1]
    v_pk_mul_f32 v[22:23], v[22:23], v[228:229] op_sel:[0,1] op_sel_hi:[1,1]
    v_pk_mul_f32 v[24:25], v[24:25], v[228:229] op_sel:[0,1] op_sel_hi:[1,1]
    v_pk_mul_f32 v[26:27], v[26:27], v[228:229] op_sel:[0,1] op_sel_hi:[1,1]
    v_pk_mul_f32 v[28:29], v[28:29], v[228:229] op_sel:[0,1] op_sel_hi:[1,1]
    v_pk_mul_f32 v[30:31], v[30:31], v[228:229] op_sel:[0,1] op_sel_hi:[1,1]
    v_cvt_pk_bf16_f32 v104, v16, v17
    v_cvt_pk_bf16_f32 v105, v18, v19
    v_cvt_pk_bf16_f32 v106, v20, v21
    v_cvt_pk_bf16_f32 v107, v22, v23
    v_cvt_pk_bf16_f32 v108, v24, v25
    v_cvt_pk_bf16_f32 v109, v26, v27
    v_cvt_pk_bf16_f32 v110, v28, v29
    v_cvt_pk_bf16_f32 v111, v30, v31
    v_mfma_f32_32x32x16_bf16 v[0:15], v[208:211], v[104:107], 0
    s_nop 0
    v_mfma_f32_32x32x16_bf16 v[16:31], v[212:215], v[108:111], 0
    s_waitcnt lgkmcnt(0)
    v_pk_fma_f32 v[32:33], v[192:193], v[228:229], v[32:33] op_sel_hi:[1,0,1] neg_lo:[0,1,0] neg_hi:[0,1,0]
    v_pk_fma_f32 v[34:35], v[194:195], v[228:229], v[34:35] op_sel_hi:[1,0,1] neg_lo:[0,1,0] neg_hi:[0,1,0]
    v_pk_fma_f32 v[36:37], v[196:197], v[228:229], v[36:37] op_sel_hi:[1,0,1] neg_lo:[0,1,0] neg_hi:[0,1,0]
    v_pk_fma_f32 v[38:39], v[198:199], v[228:229], v[38:39] op_sel_hi:[1,0,1] neg_lo:[0,1,0] neg_hi:[0,1,0]
    v_pk_fma_f32 v[40:41], v[200:201], v[228:229], v[40:41] op_sel_hi:[1,0,1] neg_lo:[0,1,0] neg_hi:[0,1,0]
    v_pk_fma_f32 v[42:43], v[202:203], v[228:229], v[42:43] op_sel_hi:[1,0,1] neg_lo:[0,1,0] neg_hi:[0,1,0]
    v_pk_fma_f32 v[44:45], v[204:205], v[228:229], v[44:45] op_sel_hi:[1,0,1] neg_lo:[0,1,0] neg_hi:[0,1,0]
    v_pk_fma_f32 v[46:47], v[206:207], v[228:229], v[46:47] op_sel_hi:[1,0,1] neg_lo:[0,1,0] neg_hi:[0,1,0]
    v_pk_mul_f32 v[32:33], v[32:33], v[228:229] op_sel:[0,1] op_sel_hi:[1,1]
    v_pk_mul_f32 v[34:35], v[34:35], v[228:229] op_sel:[0,1] op_sel_hi:[1,1]
    v_pk_mul_f32 v[36:37], v[36:37], v[228:229] op_sel:[0,1] op_sel_hi:[1,1]
    v_pk_mul_f32 v[38:39], v[38:39], v[228:229] op_sel:[0,1] op_sel_hi:[1,1]
    v_pk_mul_f32 v[40:41], v[40:41], v[228:229] op_sel:[0,1] op_sel_hi:[1,1]
    v_pk_mul_f32 v[42:43], v[42:43], v[228:229] op_sel:[0,1] op_sel_hi:[1,1]
    v_pk_mul_f32 v[44:45], v[44:45], v[228:229] op_sel:[0,1] op_sel_hi:[1,1]
    v_pk_mul_f32 v[46:47], v[46:47], v[228:229] op_sel:[0,1] op_sel_hi:[1,1]
    v_cvt_pk_bf16_f32 v112, v32, v33
    v_cvt_pk_bf16_f32 v113, v34, v35
    v_cvt_pk_bf16_f32 v114, v36, v37
    v_cvt_pk_bf16_f32 v115, v38, v39
    v_cvt_pk_bf16_f32 v116, v40, v41
    v_cvt_pk_bf16_f32 v117, v42, v43
    v_cvt_pk_bf16_f32 v118, v44, v45
    v_cvt_pk_bf16_f32 v119, v46, v47
    ds_write_b64 v140, v[112:113] offset:0
    ds_write_b64 v141, v[114:115] offset:0
    ds_write_b64 v140, v[116:117] offset:2048
    ds_write_b64 v141, v[118:119] offset:2048
    v_max3_f32 v72, v0, v1, v2
    v_max3_f32 v73, v8, v9, v10
    v_max3_f32 v76, v16, v17, v18
    v_max3_f32 v77, v24, v25, v26
    v_max3_f32 v72, v72, v3, v4
    v_max3_f32 v73, v73, v11, v12
    v_max3_f32 v76, v76, v19, v20
    v_max3_f32 v77, v77, v27, v28
    v_max3_f32 v72, v72, v5, v6
    v_max3_f32 v73, v73, v13, v14
    v_max3_f32 v76, v76, v21, v22
    v_max3_f32 v77, v77, v29, v30
    v_max_f32 v72, v72, v7
    v_max_f32 v73, v73, v15
    v_max_f32 v76, v76, v23
    v_max_f32 v77, v77, v31
    v_permlane32_swap_b32 v72, v73
    s_nop 0
    v_permlane32_swap_b32 v76, v77
    v_max_f32 v74, v72, v73
    v_max_f32 v78, v76, v77
    v_mul_f32 v74, s79, v74
    v_mul_f32 v78, s79, v78
    v_mov_b32 v75, v74
    v_mov_b32 v79, v78
    s_nop 0
    v_permlane32_swap_b32 v74, v75
    v_permlane32_swap_b32 v78, v79
    v_fma_f32 v0, v0, s79, -v74
    v_fma_f32 v1, v1, s79, -v74
    v_fma_f32 v2, v2, s79, -v74
    v_fma_f32 v3, v3, s79, -v74
    v_fma_f32 v4, v4, s79, -v74
    v_fma_f32 v5, v5, s79, -v74
    v_fma_f32 v6, v6, s79, -v74
    v_fma_f32 v7, v7, s79, -v74
    v_fma_f32 v8, v8, s79, -v75
    v_fma_f32 v9, v9, s79, -v75
    v_fma_f32 v10, v10, s79, -v75
    v_fma_f32 v11, v11, s79, -v75
    v_fma_f32 v12, v12, s79, -v75
    v_fma_f32 v13, v13, s79, -v75
    v_fma_f32 v14, v14, s79, -v75
    v_fma_f32 v15, v15, s79, -v75
    v_fma_f32 v16, v16, s79, -v78
    v_fma_f32 v17, v17, s79, -v78
    v_fma_f32 v18, v18, s79, -v78
    v_fma_f32 v19, v19, s79, -v78
    v_fma_f32 v20, v20, s79, -v78
    v_fma_f32 v21, v21, s79, -v78
    v_fma_f32 v22, v22, s79, -v78
    v_fma_f32 v23, v23, s79, -v78
    v_fma_f32 v24, v24, s79, -v79
    v_fma_f32 v25, v25, s79, -v79
    v_fma_f32 v26, v26, s79, -v79
    v_fma_f32 v27, v27, s79, -v79
    v_fma_f32 v28, v28, s79, -v79
    v_fma_f32 v29, v29, s79, -v79
    v_fma_f32 v30, v30, s79, -v79
    v_fma_f32 v31, v31, s79, -v79
    v_exp_f32 v0, v0
    v_exp_f32 v1, v1
    v_exp_f32 v2, v2
    v_exp_f32 v3, v3
    v_exp_f32 v4, v4
    v_exp_f32 v5, v5
    v_exp_f32 v6, v6
    v_exp_f32 v7, v7
    v_exp_f32 v8, v8
    v_exp_f32 v9, v9
    v_exp_f32 v10, v10
    v_exp_f32 v11, v11
    v_exp_f32 v12, v12
    v_exp_f32 v13, v13
    v_exp_f32 v14, v14
    v_exp_f32 v15, v15
    v_exp_f32 v16, v16
    v_exp_f32 v17, v17
    v_exp_f32 v18, v18
    v_exp_f32 v19, v19
    v_exp_f32 v20, v20
    v_exp_f32 v21, v21
    v_exp_f32 v22, v22
    v_exp_f32 v23, v23
    v_exp_f32 v24, v24
    v_exp_f32 v25, v25
    v_exp_f32 v26, v26
    v_exp_f32 v27, v27
    v_exp_f32 v28, v28
    v_exp_f32 v29, v29
    v_exp_f32 v30, v30
    v_exp_f32 v31, v31
    v_pk_add_f32 v[160:161], v[0:1], v[2:3]
    v_pk_add_f32 v[162:163], v[4:5], v[6:7]
    v_pk_add_f32 v[164:165], v[8:9], v[10:11]
    v_pk_add_f32 v[166:167], v[12:13], v[14:15]
    v_pk_add_f32 v[168:169], v[16:17], v[18:19]
    v_pk_add_f32 v[170:171], v[20:21], v[22:23]
    v_pk_add_f32 v[172:173], v[24:25], v[26:27]
    v_pk_add_f32 v[174:175], v[28:29], v[30:31]
    v_pk_add_f32 v[160:161], v[160:161], v[162:163]
    v_pk_add_f32 v[164:165], v[164:165], v[166:167]
    v_pk_add_f32 v[168:169], v[168:169], v[170:171]
    v_pk_add_f32 v[172:173], v[172:173], v[174:175]
    v_add_f32 v72, v160, v161
    v_add_f32 v73, v164, v165
    v_add_f32 v76, v168, v169
    v_add_f32 v77, v172, v173
    v_permlane32_swap_b32 v72, v73
    s_nop 0
    v_permlane32_swap_b32 v76, v77
    v_add_f32 v74, v72, v73
    v_add_f32 v78, v76, v77
    v_rcp_f32 v74, v74
    v_rcp_f32 v78, v78
    v_mov_b32 v75, v74
    v_mov_b32 v79, v78
    s_nop 0
    v_permlane32_swap_b32 v74, v75
    v_permlane32_swap_b32 v78, v79
    v_pk_mul_f32 v[0:1], v[0:1], v[74:75] op_sel:[0,0] op_sel_hi:[1,0]
    v_pk_mul_f32 v[2:3], v[2:3], v[74:75] op_sel:[0,0] op_sel_hi:[1,0]
    v_pk_mul_f32 v[4:5], v[4:5], v[74:75] op_sel:[0,0] op_sel_hi:[1,0]
    v_pk_mul_f32 v[6:7], v[6:7], v[74:75] op_sel:[0,0] op_sel_hi:[1,0]
    v_pk_mul_f32 v[8:9], v[8:9], v[74:75] op_sel:[0,1] op_sel_hi:[1,1]
    v_pk_mul_f32 v[10:11], v[10:11], v[74:75] op_sel:[0,1] op_sel_hi:[1,1]
    v_pk_mul_f32 v[12:13], v[12:13], v[74:75] op_sel:[0,1] op_sel_hi:[1,1]
    v_pk_mul_f32 v[14:15], v[14:15], v[74:75] op_sel:[0,1] op_sel_hi:[1,1]
    v_pk_mul_f32 v[16:17], v[16:17], v[78:79] op_sel:[0,0] op_sel_hi:[1,0]
    v_pk_mul_f32 v[18:19], v[18:19], v[78:79] op_sel:[0,0] op_sel_hi:[1,0]
    v_pk_mul_f32 v[20:21], v[20:21], v[78:79] op_sel:[0,0] op_sel_hi:[1,0]
    v_pk_mul_f32 v[22:23], v[22:23], v[78:79] op_sel:[0,0] op_sel_hi:[1,0]
    v_pk_mul_f32 v[24:25], v[24:25], v[78:79] op_sel:[0,1] op_sel_hi:[1,1]
    v_pk_mul_f32 v[26:27], v[26:27], v[78:79] op_sel:[0,1] op_sel_hi:[1,1]
    v_pk_mul_f32 v[28:29], v[28:29], v[78:79] op_sel:[0,1] op_sel_hi:[1,1]
    v_pk_mul_f32 v[30:31], v[30:31], v[78:79] op_sel:[0,1] op_sel_hi:[1,1]
    v_cvt_pk_bf16_f32 v160, v0, v1
    v_cvt_pk_bf16_f32 v161, v2, v3
    v_cvt_pk_bf16_f32 v162, v4, v5
    v_cvt_pk_bf16_f32 v163, v6, v7
    v_cvt_pk_bf16_f32 v164, v8, v9
    v_cvt_pk_bf16_f32 v165, v10, v11
    v_cvt_pk_bf16_f32 v166, v12, v13
    v_cvt_pk_bf16_f32 v167, v14, v15
    v_cvt_pk_bf16_f32 v168, v16, v17
    v_cvt_pk_bf16_f32 v169, v18, v19
    v_cvt_pk_bf16_f32 v170, v20, v21
    v_cvt_pk_bf16_f32 v171, v22, v23
    v_cvt_pk_bf16_f32 v172, v24, v25
    v_cvt_pk_bf16_f32 v173, v26, v27
    v_cvt_pk_bf16_f32 v174, v28, v29
    v_cvt_pk_bf16_f32 v175, v30, v31
    ds_write_b64 v142, v[160:161] offset:0
    ds_write_b64 v143, v[162:163] offset:0
    ds_write_b64 v120, v[164:165] offset:0
    ds_write_b64 v121, v[166:167] offset:0
    ds_write_b64 v142, v[168:169] offset:4096
    ds_write_b64 v143, v[170:171] offset:4096
    ds_write_b64 v120, v[172:173] offset:4096
    ds_write_b64 v121, v[174:175] offset:4096
    s_waitcnt lgkmcnt(0)
    s_barrier
    ds_read_b64_tr_b16 v[32:33], v122 offset:0
    ds_read_b64_tr_b16 v[34:35], v123 offset:0
    ds_read_b64_tr_b16 v[36:37], v122 offset:1024
    ds_read_b64_tr_b16 v[38:39], v123 offset:1024
    ds_read_b64_tr_b16 v[40:41], v122 offset:2048
    ds_read_b64_tr_b16 v[42:43], v123 offset:2048
    ds_read_b64_tr_b16 v[44:45], v122 offset:3072
    ds_read_b64_tr_b16 v[46:47], v123 offset:3072
    ds_read_b64_tr_b16 v[176:177], v124 offset:0
    ds_read_b64_tr_b16 v[178:179], v125 offset:0
    ds_read_b64_tr_b16 v[180:181], v124 offset:512
    ds_read_b64_tr_b16 v[182:183], v125 offset:512
    ds_read_b64_tr_b16 v[184:185], v124 offset:1024
    ds_read_b64_tr_b16 v[186:187], v125 offset:1024
    ds_read_b64_tr_b16 v[188:189], v124 offset:1536
    ds_read_b64_tr_b16 v[190:191], v125 offset:1536
    v_cmp_le_u32 vcc, 16, v145
    s_waitcnt lgkmcnt(0)
    s_nop 0
    v_cndmask_b32 v176, v176, v68, vcc
    v_cndmask_b32 v177, v177, v68, vcc
    v_cndmask_b32 v178, v178, v68, vcc
    v_cndmask_b32 v179, v179, v68, vcc
    v_cndmask_b32 v180, v180, v68, vcc
    v_cndmask_b32 v181, v181, v68, vcc
    v_cndmask_b32 v182, v182, v68, vcc
    v_cndmask_b32 v183, v183, v68, vcc
    v_cndmask_b32 v184, v184, v68, vcc
    v_cndmask_b32 v185, v185, v68, vcc
    v_cndmask_b32 v186, v186, v68, vcc
    v_cndmask_b32 v187, v187, v68, vcc
    v_cndmask_b32 v188, v188, v68, vcc
    v_cndmask_b32 v189, v189, v68, vcc
    v_cndmask_b32 v190, v190, v68, vcc
    v_cndmask_b32 v191, v191, v68, vcc
    v_mfma_f32_32x32x16_bf16 v[16:31], v[32:35], v[176:179], 0
    v_mfma_f32_32x32x16_bf16 v[16:31], v[36:39], v[180:183], v[16:31]
    v_mfma_f32_32x32x16_bf16 v[16:31], v[40:43], v[184:187], v[16:31]
    v_mfma_f32_32x32x16_bf16 v[16:31], v[44:47], v[188:191], v[16:31]
    ds_read_b128 v[72:75], v128 offset:0
    ds_read_b64_tr_b16 v[76:77], v135 offset:0
    ds_read_b64_tr_b16 v[78:79], v135 offset:512
    ds_read_b128 v[80:83], v129 offset:0
    ds_read_b64_tr_b16 v[84:85], v135 offset:2048
    ds_read_b64_tr_b16 v[86:87], v135 offset:2560
    ds_read_b64_tr_b16 v[104:105], v137 offset:0
    ds_read_b64_tr_b16 v[106:107], v137 offset:512
    ds_read_b128 v[88:91], v130 offset:0
    ds_read_b64_tr_b16 v[92:93], v135 offset:4096
    ds_read_b64_tr_b16 v[94:95], v135 offset:4608
    s_nop 0
    v_cvt_pk_bf16_f32 v176, v16, v17
    v_cvt_pk_bf16_f32 v177, v18, v19
    v_cvt_pk_bf16_f32 v178, v20, v21
    v_cvt_pk_bf16_f32 v179, v22, v23
    v_cvt_pk_bf16_f32 v180, v24, v25
    v_cvt_pk_bf16_f32 v181, v26, v27
    v_cvt_pk_bf16_f32 v182, v28, v29
    v_cvt_pk_bf16_f32 v183, v30, v31
    s_mov_b32 exec_lo, 0x1ffff
    s_mov_b32 exec_hi, 0x1ffff
    buffer_store_dwordx4 v[176:179], v156, s[40:43], s88 offen offset:0 sc1
    buffer_store_dwordx4 v[180:183], v156, s[40:43], s88 offen offset:544 sc1
    s_mov_b64 exec, -1
    s_waitcnt lgkmcnt(8)
    v_mfma_f32_32x32x16_bf16 v[48:63], v[76:79], v[72:75], 0
    ds_read_b128 v[96:99], v131 offset:0
    ds_read_b64_tr_b16 v[100:101], v135 offset:6144
    ds_read_b64_tr_b16 v[102:103], v135 offset:6656
    ds_read_b64_tr_b16 v[108:109], v137 offset:4096
    ds_read_b64_tr_b16 v[110:111], v137 offset:4608
    s_waitcnt lgkmcnt(8)
    v_mfma_f32_32x32x16_bf16 v[48:63], v[84:87], v[80:83], v[48:63]
    v_mfma_f32_16x16x32_bf16 v[64:67], v[104:107], v[68:71], 0
    ds_read_b128 v[72:75], v128 offset:8192
    ds_read_b64_tr_b16 v[76:77], v135 offset:8192
    ds_read_b64_tr_b16 v[78:79], v135 offset:8704
    s_waitcnt lgkmcnt(8)
    v_mfma_f32_32x32x16_bf16 v[48:63], v[92:95], v[88:91], v[48:63]
    ds_read_b128 v[80:83], v129 offset:8192
    ds_read_b64_tr_b16 v[84:85], v135 offset:10240
    ds_read_b64_tr_b16 v[86:87], v135 offset:10752
    ds_read_b64_tr_b16 v[104:105], v137 offset:8192
    ds_read_b64_tr_b16 v[106:107], v137 offset:8704
    s_waitcnt lgkmcnt(8)
    v_mfma_f32_32x32x16_bf16 v[48:63], v[100:103], v[96:99], v[48:63]
    v_mfma_f32_16x16x32_bf16 v[64:67], v[108:111], v[68:71], v[64:67]
    ds_read_b128 v[88:91], v130 offset:8192
    ds_read_b64_tr_b16 v[92:93], v135 offset:12288
    ds_read_b64_tr_b16 v[94:95], v135 offset:12800
    s_waitcnt lgkmcnt(8)
    v_mfma_f32_32x32x16_bf16 v[48:63], v[76:79], v[72:75], v[48:63]
    ds_read_b128 v[96:99], v131 offset:8192
    ds_read_b64_tr_b16 v[100:101], v135 offset:14336
    ds_read_b64_tr_b16 v[102:103], v135 offset:14848
    ds_read_b64_tr_b16 v[108:109], v137 offset:12288
    ds_read_b64_tr_b16 v[110:111], v137 offset:12800
    s_waitcnt lgkmcnt(8)
    v_mfma_f32_32x32x16_bf16 v[48:63], v[84:87], v[80:83], v[48:63]
    v_mfma_f32_16x16x32_bf16 v[64:67], v[104:107], v[68:71], v[64:67]
    ds_read_b128 v[72:75], v128 offset:16384
    ds_read_b64_tr_b16 v[76:77], v135 offset:16384
    ds_read_b64_tr_b16 v[78:79], v135 offset:16896
    s_waitcnt lgkmcnt(8)
    v_mfma_f32_32x32x16_bf16 v[48:63], v[92:95], v[88:91], v[48:63]
    ds_read_b128 v[80:83], v129 offset:16384
    ds_read_b64_tr_b16 v[84:85], v135 offset:18432
    ds_read_b64_tr_b16 v[86:87], v135 offset:18944
    ds_read_b64_tr_b16 v[104:105], v137 offset:16384
    ds_read_b64_tr_b16 v[106:107], v137 offset:16896
    s_waitcnt lgkmcnt(8)
    v_mfma_f32_32x32x16_bf16 v[48:63], v[100:103], v[96:99], v[48:63]
    v_mfma_f32_16x16x32_bf16 v[64:67], v[108:111], v[68:71], v[64:67]
    ds_read_b128 v[88:91], v130 offset:16384
    ds_read_b64_tr_b16 v[92:93], v135 offset:20480
    ds_read_b64_tr_b16 v[94:95], v135 offset:20992
    s_waitcnt lgkmcnt(8)
    v_mfma_f32_32x32x16_bf16 v[48:63], v[76:79], v[72:75], v[48:63]
    ds_read_b128 v[96:99], v131 offset:16384
    ds_read_b64_tr_b16 v[100:101], v135 offset:22528
    ds_read_b64_tr_b16 v[102:103], v135 offset:23040
    ds_read_b64_tr_b16 v[108:109], v137 offset:20480
    ds_read_b64_tr_b16 v[110:111], v137 offset:20992
    s_waitcnt lgkmcnt(8)
    v_mfma_f32_32x32x16_bf16 v[48:63], v[84:87], v[80:83], v[48:63]
    v_mfma_f32_16x16x32_bf16 v[64:67], v[104:107], v[68:71], v[64:67]
    ds_read_b128 v[72:75], v128 offset:24576
    ds_read_b64_tr_b16 v[76:77], v135 offset:24576
    ds_read_b64_tr_b16 v[78:79], v135 offset:25088
    s_waitcnt lgkmcnt(8)
    v_mfma_f32_32x32x16_bf16 v[48:63], v[92:95], v[88:91], v[48:63]
    ds_read_b128 v[80:83], v129 offset:24576
    ds_read_b64_tr_b16 v[84:85], v135 offset:26624
    ds_read_b64_tr_b16 v[86:87], v135 offset:27136
    ds_read_b64_tr_b16 v[104:105], v137 offset:24576
    ds_read_b64_tr_b16 v[106:107], v137 offset:25088
    s_waitcnt lgkmcnt(8)
    v_mfma_f32_32x32x16_bf16 v[48:63], v[100:103], v[96:99], v[48:63]
    v_mfma_f32_16x16x32_bf16 v[64:67], v[108:111], v[68:71], v[64:67]
    ds_read_b128 v[88:91], v130 offset:24576
    ds_read_b64_tr_b16 v[92:93], v135 offset:28672
    ds_read_b64_tr_b16 v[94:95], v135 offset:29184
    s_waitcnt lgkmcnt(8)
    v_mfma_f32_32x32x16_bf16 v[48:63], v[76:79], v[72:75], v[48:63]
    ds_read_b128 v[96:99], v131 offset:24576
    ds_read_b64_tr_b16 v[100:101], v135 offset:30720
    ds_read_b64_tr_b16 v[102:103], v135 offset:31232
    ds_read_b64_tr_b16 v[108:109], v137 offset:28672
    ds_read_b64_tr_b16 v[110:111], v137 offset:29184
    s_waitcnt lgkmcnt(8)
    v_mfma_f32_32x32x16_bf16 v[48:63], v[84:87], v[80:83], v[48:63]
    v_mfma_f32_16x16x32_bf16 v[64:67], v[104:107], v[68:71], v[64:67]
    ds_read_b128 v[72:75], v128 offset:32768
    ds_read_b64_tr_b16 v[76:77], v135 offset:32768
    ds_read_b64_tr_b16 v[78:79], v135 offset:33280
    s_waitcnt lgkmcnt(8)
    v_mfma_f32_32x32x16_bf16 v[48:63], v[92:95], v[88:91], v[48:63]
    ds_read_b128 v[80:83], v129 offset:32768
    ds_read_b64_tr_b16 v[84:85], v135 offset:34816
    ds_read_b64_tr_b16 v[86:87], v135 offset:35328
    ds_read_b64_tr_b16 v[104:105], v137 offset:32768
    ds_read_b64_tr_b16 v[106:107], v137 offset:33280
    s_waitcnt lgkmcnt(8)
    v_mfma_f32_32x32x16_bf16 v[48:63], v[100:103], v[96:99], v[48:63]
    v_mfma_f32_16x16x32_bf16 v[64:67], v[108:111], v[68:71], v[64:67]
    s_barrier
    ds_read_b128 v[88:91], v130 offset:32768
    ds_read_b64_tr_b16 v[92:93], v135 offset:36864
    ds_read_b64_tr_b16 v[94:95], v135 offset:37376
    s_waitcnt lgkmcnt(8)
    v_mfma_f32_32x32x16_bf16 v[48:63], v[76:79], v[72:75], v[48:63]
    ds_read_b128 v[96:99], v131 offset:32768
    ds_read_b64_tr_b16 v[100:101], v135 offset:38912
    ds_read_b64_tr_b16 v[102:103], v135 offset:39424
    ds_read_b64_tr_b16 v[108:109], v137 offset:36864
    ds_read_b64_tr_b16 v[110:111], v137 offset:37376
    s_waitcnt lgkmcnt(8)
    v_mfma_f32_32x32x16_bf16 v[48:63], v[84:87], v[80:83], v[48:63]
    v_mfma_f32_16x16x32_bf16 v[64:67], v[104:107], v[68:71], v[64:67]
    ds_read_b128 v[72:75], v128 offset:40960
    ds_read_b64_tr_b16 v[76:77], v135 offset:40960
    ds_read_b64_tr_b16 v[78:79], v135 offset:41472
    s_waitcnt lgkmcnt(8)
    v_mfma_f32_32x32x16_bf16 v[48:63], v[92:95], v[88:91], v[48:63]
    ds_read_b128 v[80:83], v129 offset:40960
    ds_read_b64_tr_b16 v[84:85], v135 offset:43008
    ds_read_b64_tr_b16 v[86:87], v135 offset:43520
    ds_read_b64_tr_b16 v[104:105], v137 offset:40960
    ds_read_b64_tr_b16 v[106:107], v137 offset:41472
    s_waitcnt lgkmcnt(8)
    v_mfma_f32_32x32x16_bf16 v[48:63], v[100:103], v[96:99], v[48:63]
    v_mfma_f32_16x16x32_bf16 v[64:67], v[108:111], v[68:71], v[64:67]
    ds_read_b128 v[88:91], v130 offset:40960
    ds_read_b64_tr_b16 v[92:93], v135 offset:45056
    ds_read_b64_tr_b16 v[94:95], v135 offset:45568
    s_waitcnt lgkmcnt(8)
    v_mfma_f32_32x32x16_bf16 v[48:63], v[76:79], v[72:75], v[48:63]
    ds_read_b128 v[96:99], v131 offset:40960
    ds_read_b64_tr_b16 v[100:101], v135 offset:47104
    ds_read_b64_tr_b16 v[102:103], v135 offset:47616
    ds_read_b64_tr_b16 v[108:109], v137 offset:45056
    ds_read_b64_tr_b16 v[110:111], v137 offset:45568
    s_waitcnt lgkmcnt(8)
    v_mfma_f32_32x32x16_bf16 v[48:63], v[84:87], v[80:83], v[48:63]
    v_mfma_f32_16x16x32_bf16 v[64:67], v[104:107], v[68:71], v[64:67]
    ds_read_b128 v[72:75], v128 offset:49152
    ds_read_b64_tr_b16 v[76:77], v135 offset:49152
    ds_read_b64_tr_b16 v[78:79], v135 offset:49664
    s_waitcnt lgkmcnt(8)
    v_mfma_f32_32x32x16_bf16 v[48:63], v[92:95], v[88:91], v[48:63]
    ds_read_b128 v[80:83], v129 offset:49152
    ds_read_b64_tr_b16 v[84:85], v135 offset:51200
    ds_read_b64_tr_b16 v[86:87], v135 offset:51712
    ds_read_b64_tr_b16 v[104:105], v137 offset:49152
    ds_read_b64_tr_b16 v[106:107], v137 offset:49664
    s_waitcnt lgkmcnt(8)
    v_mfma_f32_32x32x16_bf16 v[48:63], v[100:103], v[96:99], v[48:63]
    v_mfma_f32_16x16x32_bf16 v[64:67], v[108:111], v[68:71], v[64:67]
    ds_read_b128 v[88:91], v130 offset:49152
    ds_read_b64_tr_b16 v[92:93], v135 offset:53248
    ds_read_b64_tr_b16 v[94:95], v135 offset:53760
    s_waitcnt lgkmcnt(8)
    v_mfma_f32_32x32x16_bf16 v[48:63], v[76:79], v[72:75], v[48:63]
    ds_read_b128 v[96:99], v131 offset:49152
    ds_read_b64_tr_b16 v[100:101], v135 offset:55296
    ds_read_b64_tr_b16 v[102:103], v135 offset:55808
    ds_read_b64_tr_b16 v[108:109], v137 offset:53248
    ds_read_b64_tr_b16 v[110:111], v137 offset:53760
    s_waitcnt lgkmcnt(8)
    v_mfma_f32_32x32x16_bf16 v[48:63], v[84:87], v[80:83], v[48:63]
    v_mfma_f32_16x16x32_bf16 v[64:67], v[104:107], v[68:71], v[64:67]
    ds_read_b128 v[72:75], v128 offset:57344
    ds_read_b64_tr_b16 v[76:77], v135 offset:57344
    ds_read_b64_tr_b16 v[78:79], v135 offset:57856
    s_waitcnt lgkmcnt(8)
    v_mfma_f32_32x32x16_bf16 v[48:63], v[92:95], v[88:91], v[48:63]
    ds_read_b128 v[80:83], v129 offset:57344
    ds_read_b64_tr_b16 v[84:85], v135 offset:59392
    ds_read_b64_tr_b16 v[86:87], v135 offset:59904
    ds_read_b64_tr_b16 v[104:105], v137 offset:57344
    ds_read_b64_tr_b16 v[106:107], v137 offset:57856
    s_waitcnt lgkmcnt(8)
    v_mfma_f32_32x32x16_bf16 v[48:63], v[100:103], v[96:99], v[48:63]
    v_mfma_f32_16x16x32_bf16 v[64:67], v[108:111], v[68:71], v[64:67]
    ds_read_b128 v[88:91], v130 offset:57344
    ds_read_b64_tr_b16 v[92:93], v135 offset:61440
    ds_read_b64_tr_b16 v[94:95], v135 offset:61952
    s_waitcnt lgkmcnt(8)
    v_mfma_f32_32x32x16_bf16 v[48:63], v[76:79], v[72:75], v[48:63]
    ds_read_b128 v[96:99], v131 offset:57344
    ds_read_b64_tr_b16 v[100:101], v135 offset:63488
    ds_read_b64_tr_b16 v[102:103], v135 offset:64000
    ds_read_b64_tr_b16 v[108:109], v137 offset:61440
    ds_read_b64_tr_b16 v[110:111], v137 offset:61952
    s_waitcnt lgkmcnt(8)
    v_mfma_f32_32x32x16_bf16 v[48:63], v[84:87], v[80:83], v[48:63]
    v_mfma_f32_16x16x32_bf16 v[64:67], v[104:107], v[68:71], v[64:67]
    s_waitcnt lgkmcnt(5)
    v_mfma_f32_32x32x16_bf16 v[48:63], v[92:95], v[88:91], v[48:63]
    s_waitcnt lgkmcnt(0)
    v_mfma_f32_32x32x16_bf16 v[48:63], v[100:103], v[96:99], v[48:63]
    v_mfma_f32_16x16x32_bf16 v[64:67], v[108:111], v[68:71], v[64:67]
    s_mov_b32 exec_lo, 0x10001
    s_mov_b32 exec_hi, 0x10001
    s_nop 5
    ds_write_b128 v224, v[64:67]
    s_mov_b64 exec, -1
    s_waitcnt lgkmcnt(0)
    s_barrier
    ds_read_b128 v[100:103], v138 offset:0
    ds_read_b128 v[104:107], v138 offset:32
    ds_read_b128 v[108:111], v138 offset:64
    ds_read_b128 v[112:115], v138 offset:96
    s_waitcnt lgkmcnt(0)
    s_cmp_lg_u32 s83, -1
    s_cbranch_scc1 L_RED
    ds_read_b64_tr_b16 v[72:73], v216 offset:0
    ds_read_b64_tr_b16 v[74:75], v216 offset:768
    ds_read_b128 v[84:87], v222 offset:0
    ds_read_b128 v[88:91], v222 offset:2048
    ds_read_b128 v[92:95], v222 offset:4096
    ds_read_b128 v[96:99], v222 offset:6144
    ds_read_b64_tr_b16 v[76:77], v217 offset:0
    ds_read_b64_tr_b16 v[78:79], v217 offset:768
    ds_read_b64_tr_b16 v[80:81], v218 offset:0
    ds_read_b64_tr_b16 v[82:83], v218 offset:768
    s_waitcnt lgkmcnt(7)
    v_mfma_f32_16x16x32_bf16 v[0:3], v[72:75], v[84:87], 0
    ds_read_b64_tr_b16 v[160:161], v216 offset:6144
    v_fma_f32 v48, -v228, v100, v48
    v_fma_f32 v49, -v228, v101, v49
    v_fma_f32 v50, -v228, v102, v50
    s_waitcnt lgkmcnt(7)
    v_mfma_f32_16x16x32_bf16 v[4:7], v[72:75], v[88:91], 0
    ds_read_b64_tr_b16 v[162:163], v216 offset:6912
    v_fma_f32 v51, -v228, v103, v51
    v_fma_f32 v52, -v228, v104, v52
    s_waitcnt lgkmcnt(7)
    v_mfma_f32_16x16x32_bf16 v[8:11], v[72:75], v[92:95], 0
    ds_read_b128 v[172:175], v222 offset:1024
    v_fma_f32 v53, -v228, v105, v53
    v_fma_f32 v54, -v228, v106, v54
    s_waitcnt lgkmcnt(7)
    v_mfma_f32_16x16x32_bf16 v[12:15], v[72:75], v[96:99], 0
    ds_read_b128 v[176:179], v222 offset:3072
    v_fma_f32 v55, -v228, v107, v55
    v_fma_f32 v56, -v228, v108, v56
    s_waitcnt lgkmcnt(6)
    v_mfma_f32_16x16x32_bf16 v[16:19], v[76:79], v[84:87], 0
    ds_read_b128 v[180:183], v222 offset:5120
    v_fma_f32 v57, -v228, v109, v57
    v_fma_f32 v58, -v228, v110, v58
    v_mfma_f32_16x16x32_bf16 v[20:23], v[76:79], v[88:91], 0
    ds_read_b128 v[184:187], v222 offset:7168
    v_fma_f32 v59, -v228, v111, v59
    v_fma_f32 v60, -v228, v112, v60
    v_mfma_f32_16x16x32_bf16 v[24:27], v[76:79], v[92:95], 0
    ds_read_b64_tr_b16 v[164:165], v217 offset:6144
    v_fma_f32 v61, -v228, v113, v61
    v_fma_f32 v62, -v228, v114, v62
    v_mfma_f32_16x16x32_bf16 v[28:31], v[76:79], v[96:99], 0
    ds_read_b64_tr_b16 v[166:167], v217 offset:6912
    v_fma_f32 v63, -v228, v115, v63
    v_mul_f32 v48, v48, v229
    s_waitcnt lgkmcnt(8)
    v_mfma_f32_16x16x32_bf16 v[32:35], v[80:83], v[84:87], 0
    ds_read_b64_tr_b16 v[168:169], v218 offset:6144
    v_mul_f32 v49, v49, v229
    v_mul_f32 v50, v50, v229
    v_mfma_f32_16x16x32_bf16 v[36:39], v[80:83], v[88:91], 0
    ds_read_b64_tr_b16 v[170:171], v218 offset:6912
    v_mul_f32 v51, v51, v229
    v_mul_f32 v52, v52, v229
    v_mfma_f32_16x16x32_bf16 v[40:43], v[80:83], v[92:95], 0
    v_mul_f32 v53, v53, v229
    v_mul_f32 v54, v54, v229
    v_mfma_f32_16x16x32_bf16 v[44:47], v[80:83], v[96:99], 0
    v_mul_f32 v55, v55, v229
    v_mul_f32 v56, v56, v229
    s_waitcnt lgkmcnt(7)
    v_mfma_f32_16x16x32_bf16 v[0:3], v[160:163], v[172:175], v[0:3]
    s_waitcnt lgkmcnt(0)
    s_barrier
    ds_read_b64_tr_b16 v[72:73], v219 offset:0
    v_mul_f32 v57, v57, v229
    v_mul_f32 v58, v58, v229
    v_mfma_f32_16x16x32_bf16 v[4:7], v[160:163], v[176:179], v[4:7]
    ds_read_b64_tr_b16 v[74:75], v219 offset:768
    v_mul_f32 v59, v59, v229
    v_mul_f32 v60, v60, v229
    v_mfma_f32_16x16x32_bf16 v[8:11], v[160:163], v[180:183], v[8:11]
    ds_read_b128 v[84:87], v223 offset:0
    v_mul_f32 v61, v61, v229
    v_mul_f32 v62, v62, v229
    v_mfma_f32_16x16x32_bf16 v[12:15], v[160:163], v[184:187], v[12:15]
    ds_read_b128 v[88:91], v223 offset:2048
    v_mul_f32 v63, v63, v229
    v_cvt_pk_bf16_f32 v116, v48, v49
    v_mfma_f32_16x16x32_bf16 v[16:19], v[164:167], v[172:175], v[16:19]
    ds_read_b128 v[92:95], v223 offset:4096
    v_cvt_pk_bf16_f32 v117, v50, v51
    v_cvt_pk_bf16_f32 v118, v52, v53
    v_mfma_f32_16x16x32_bf16 v[20:23], v[164:167], v[176:179], v[20:23]
    ds_read_b128 v[96:99], v223 offset:6144
    v_cvt_pk_bf16_f32 v119, v54, v55
    v_cvt_pk_bf16_f32 v120, v56, v57
    v_mfma_f32_16x16x32_bf16 v[24:27], v[164:167], v[180:183], v[24:27]
    ds_read_b64_tr_b16 v[76:77], v220 offset:0
    v_cvt_pk_bf16_f32 v121, v58, v59
    v_cvt_pk_bf16_f32 v122, v60, v61
    v_mfma_f32_16x16x32_bf16 v[28:31], v[164:167], v[184:187], v[28:31]
    ds_read_b64_tr_b16 v[78:79], v220 offset:768
    v_cvt_pk_bf16_f32 v123, v62, v63
    v_mfma_f32_32x32x16_bf16 v[100:115], v[208:211], v[116:119], 0
    v_mfma_f32_16x16x32_bf16 v[32:35], v[168:171], v[172:175], v[32:35]
    ds_read_b64_tr_b16 v[80:81], v221 offset:0
    v_mfma_f32_32x32x16_bf16 v[48:63], v[212:215], v[120:123], 0
    s_mov_b32 s32, s10
    v_mfma_f32_16x16x32_bf16 v[36:39], v[168:171], v[176:179], v[36:39]
    ds_read_b64_tr_b16 v[82:83], v221 offset:768
    s_mov_b32 s33, s11
    s_mov_b32 s34, 524288
    v_mfma_f32_16x16x32_bf16 v[40:43], v[168:171], v[180:183], v[40:43]
    s_mov_b32 s35, 0x20000
    s_mov_b32 s56, s18
    v_mfma_f32_16x16x32_bf16 v[44:47], v[168:171], v[184:187], v[44:47]
    s_mov_b32 s57, s19
    s_mov_b32 s58, 5636096
    s_waitcnt lgkmcnt(7)
    v_mfma_f32_16x16x32_bf16 v[0:3], v[72:75], v[84:87], v[0:3]
    ds_read_b64_tr_b16 v[160:161], v219 offset:6144
    s_mov_b32 s59, 0x20000
    s_mov_b32 s44, s16
    s_waitcnt lgkmcnt(7)
    v_mfma_f32_16x16x32_bf16 v[4:7], v[72:75], v[88:91], v[4:7]
    ds_read_b64_tr_b16 v[162:163], v219 offset:6912
    s_mov_b32 s45, s17
    s_mov_b32 s46, 2752
    s_mov_b32 s47, 0x20000
    s_waitcnt lgkmcnt(7)
    v_mfma_f32_16x16x32_bf16 v[8:11], v[72:75], v[92:95], v[8:11]
    ds_read_b128 v[172:175], v223 offset:1024
    v_max3_f32 v128, v100, v101, v102
    v_max3_f32 v129, v108, v109, v110
    s_waitcnt lgkmcnt(7)
    v_mfma_f32_16x16x32_bf16 v[12:15], v[72:75], v[96:99], v[12:15]
    ds_read_b128 v[176:179], v223 offset:3072
    v_max3_f32 v132, v48, v49, v50
    v_max3_f32 v133, v56, v57, v58
    s_waitcnt lgkmcnt(6)
    v_mfma_f32_16x16x32_bf16 v[16:19], v[76:79], v[84:87], v[16:19]
    ds_read_b128 v[180:183], v223 offset:5120
    v_max3_f32 v128, v128, v103, v104
    v_max3_f32 v129, v129, v111, v112
    v_mfma_f32_16x16x32_bf16 v[20:23], v[76:79], v[88:91], v[20:23]
    ds_read_b128 v[184:187], v223 offset:7168
    v_max3_f32 v132, v132, v51, v52
    v_max3_f32 v133, v133, v59, v60
    v_mfma_f32_16x16x32_bf16 v[24:27], v[76:79], v[92:95], v[24:27]
    ds_read_b64_tr_b16 v[164:165], v220 offset:6144
    v_max3_f32 v128, v128, v105, v106
    v_max3_f32 v129, v129, v113, v114
    v_mfma_f32_16x16x32_bf16 v[28:31], v[76:79], v[96:99], v[28:31]
    ds_read_b64_tr_b16 v[166:167], v220 offset:6912
    v_max3_f32 v132, v132, v53, v54
    v_max3_f32 v133, v133, v61, v62
    s_waitcnt lgkmcnt(8)
    v_mfma_f32_16x16x32_bf16 v[32:35], v[80:83], v[84:87], v[32:35]
    ds_read_b64_tr_b16 v[168:169], v221 offset:6144
    v_max_f32 v128, v128, v107
    v_max_f32 v129, v129, v115
    v_mfma_f32_16x16x32_bf16 v[36:39], v[80:83], v[88:91], v[36:39]
    ds_read_b64_tr_b16 v[170:171], v221 offset:6912
    v_max_f32 v132, v132, v55
    v_max_f32 v133, v133, v63
    v_mfma_f32_16x16x32_bf16 v[40:43], v[80:83], v[92:95], v[40:43]
    v_permlane32_swap_b32 v128, v129
    v_permlane32_swap_b32 v132, v133
    v_mfma_f32_16x16x32_bf16 v[44:47], v[80:83], v[96:99], v[44:47]
    v_max_f32 v130, v128, v129
    v_max_f32 v134, v132, v133
    s_waitcnt lgkmcnt(7)
    v_mfma_f32_16x16x32_bf16 v[0:3], v[160:163], v[172:175], v[0:3]
    s_waitcnt lgkmcnt(0)
    s_barrier
    ds_read_b64_tr_b16 v[72:73], v216 offset:32768
    v_mul_f32 v130, s79, v130
    v_mul_f32 v134, s79, v134
    v_mfma_f32_16x16x32_bf16 v[4:7], v[160:163], v[176:179], v[4:7]
    ds_read_b64_tr_b16 v[74:75], v216 offset:33536
    v_mov_b32 v131, v130
    v_mov_b32 v135, v134
    v_mfma_f32_16x16x32_bf16 v[8:11], v[160:163], v[180:183], v[8:11]
    ds_read_b128 v[84:87], v222 offset:32768
    v_permlane32_swap_b32 v130, v131
    v_permlane32_swap_b32 v134, v135
    v_mfma_f32_16x16x32_bf16 v[12:15], v[160:163], v[184:187], v[12:15]
    ds_read_b128 v[88:91], v222 offset:34816
    v_fma_f32 v100, v100, s79, -v130
    v_fma_f32 v101, v101, s79, -v130
    v_mfma_f32_16x16x32_bf16 v[16:19], v[164:167], v[172:175], v[16:19]
    ds_read_b128 v[92:95], v222 offset:36864
    v_fma_f32 v102, v102, s79, -v130
    v_fma_f32 v103, v103, s79, -v130
    v_mfma_f32_16x16x32_bf16 v[20:23], v[164:167], v[176:179], v[20:23]
    ds_read_b128 v[96:99], v222 offset:38912
    v_fma_f32 v104, v104, s79, -v130
    v_fma_f32 v105, v105, s79, -v130
    v_mfma_f32_16x16x32_bf16 v[24:27], v[164:167], v[180:183], v[24:27]
    ds_read_b64_tr_b16 v[76:77], v217 offset:32768
    v_fma_f32 v106, v106, s79, -v130
    v_fma_f32 v107, v107, s79, -v130
    v_mfma_f32_16x16x32_bf16 v[28:31], v[164:167], v[184:187], v[28:31]
    ds_read_b64_tr_b16 v[78:79], v217 offset:33536
    v_fma_f32 v108, v108, s79, -v131
    v_fma_f32 v109, v109, s79, -v131
    v_mfma_f32_16x16x32_bf16 v[32:35], v[168:171], v[172:175], v[32:35]
    ds_read_b64_tr_b16 v[80:81], v218 offset:32768
    v_fma_f32 v110, v110, s79, -v131
    v_fma_f32 v111, v111, s79, -v131
    v_mfma_f32_16x16x32_bf16 v[36:39], v[168:171], v[176:179], v[36:39]
    ds_read_b64_tr_b16 v[82:83], v218 offset:33536
    v_fma_f32 v112, v112, s79, -v131
    v_fma_f32 v113, v113, s79, -v131
    v_mfma_f32_16x16x32_bf16 v[40:43], v[168:171], v[180:183], v[40:43]
    v_fma_f32 v114, v114, s79, -v131
    v_fma_f32 v115, v115, s79, -v131
    v_mfma_f32_16x16x32_bf16 v[44:47], v[168:171], v[184:187], v[44:47]
    v_fma_f32 v48, v48, s79, -v134
    v_fma_f32 v49, v49, s79, -v134
    s_waitcnt lgkmcnt(7)
    v_mfma_f32_16x16x32_bf16 v[0:3], v[72:75], v[84:87], v[0:3]
    ds_read_b64_tr_b16 v[160:161], v216 offset:38912
    v_fma_f32 v50, v50, s79, -v134
    v_fma_f32 v51, v51, s79, -v134
    s_waitcnt lgkmcnt(7)
    v_mfma_f32_16x16x32_bf16 v[4:7], v[72:75], v[88:91], v[4:7]
    ds_read_b64_tr_b16 v[162:163], v216 offset:39680
    v_fma_f32 v52, v52, s79, -v134
    v_fma_f32 v53, v53, s79, -v134
    s_waitcnt lgkmcnt(7)
    v_mfma_f32_16x16x32_bf16 v[8:11], v[72:75], v[92:95], v[8:11]
    ds_read_b128 v[172:175], v222 offset:33792
    v_fma_f32 v54, v54, s79, -v134
    v_fma_f32 v55, v55, s79, -v134
    s_waitcnt lgkmcnt(7)
    v_mfma_f32_16x16x32_bf16 v[12:15], v[72:75], v[96:99], v[12:15]
    ds_read_b128 v[176:179], v222 offset:35840
    v_fma_f32 v56, v56, s79, -v135
    v_fma_f32 v57, v57, s79, -v135
    v_fma_f32 v58, v58, s79, -v135
    s_waitcnt lgkmcnt(6)
    v_mfma_f32_16x16x32_bf16 v[16:19], v[76:79], v[84:87], v[16:19]
    ds_read_b128 v[180:183], v222 offset:37888
    v_fma_f32 v59, v59, s79, -v135
    v_fma_f32 v60, v60, s79, -v135
    v_mfma_f32_16x16x32_bf16 v[20:23], v[76:79], v[88:91], v[20:23]
    ds_read_b128 v[184:187], v222 offset:39936
    v_fma_f32 v61, v61, s79, -v135
    v_fma_f32 v62, v62, s79, -v135
    v_mfma_f32_16x16x32_bf16 v[24:27], v[76:79], v[92:95], v[24:27]
    ds_read_b64_tr_b16 v[164:165], v217 offset:38912
    v_fma_f32 v63, v63, s79, -v135
    v_exp_f32 v100, v100
    v_mfma_f32_16x16x32_bf16 v[28:31], v[76:79], v[96:99], v[28:31]
    ds_read_b64_tr_b16 v[166:167], v217 offset:39680
    v_exp_f32 v101, v101
    v_exp_f32 v102, v102
    s_waitcnt lgkmcnt(8)
    v_mfma_f32_16x16x32_bf16 v[32:35], v[80:83], v[84:87], v[32:35]
    ds_read_b64_tr_b16 v[168:169], v218 offset:38912
    v_exp_f32 v103, v103
    v_exp_f32 v104, v104
    v_mfma_f32_16x16x32_bf16 v[36:39], v[80:83], v[88:91], v[36:39]
    ds_read_b64_tr_b16 v[170:171], v218 offset:39680
    v_exp_f32 v105, v105
    v_exp_f32 v106, v106
    v_mfma_f32_16x16x32_bf16 v[40:43], v[80:83], v[92:95], v[40:43]
    v_exp_f32 v107, v107
    v_exp_f32 v108, v108
    v_mfma_f32_16x16x32_bf16 v[44:47], v[80:83], v[96:99], v[44:47]
    v_exp_f32 v109, v109
    v_exp_f32 v110, v110
    s_waitcnt lgkmcnt(7)
    v_mfma_f32_16x16x32_bf16 v[0:3], v[160:163], v[172:175], v[0:3]
    s_waitcnt lgkmcnt(0)
    s_barrier
    ds_read_b64_tr_b16 v[72:73], v219 offset:32768
    v_exp_f32 v111, v111
    v_exp_f32 v112, v112
    v_mfma_f32_16x16x32_bf16 v[4:7], v[160:163], v[176:179], v[4:7]
    ds_read_b64_tr_b16 v[74:75], v219 offset:33536
    v_exp_f32 v113, v113
    v_exp_f32 v114, v114
    v_mfma_f32_16x16x32_bf16 v[8:11], v[160:163], v[180:183], v[8:11]
    ds_read_b128 v[84:87], v223 offset:32768
    v_exp_f32 v115, v115
    v_exp_f32 v48, v48
    v_mfma_f32_16x16x32_bf16 v[12:15], v[160:163], v[184:187], v[12:15]
    ds_read_b128 v[88:91], v223 offset:34816
    v_exp_f32 v49, v49
    v_exp_f32 v50, v50
    v_mfma_f32_16x16x32_bf16 v[16:19], v[164:167], v[172:175], v[16:19]
    ds_read_b128 v[92:95], v223 offset:36864
    v_exp_f32 v51, v51
    v_exp_f32 v52, v52
    v_mfma_f32_16x16x32_bf16 v[20:23], v[164:167], v[176:179], v[20:23]
    ds_read_b128 v[96:99], v223 offset:38912
    v_exp_f32 v53, v53
    v_exp_f32 v54, v54
    v_mfma_f32_16x16x32_bf16 v[24:27], v[164:167], v[180:183], v[24:27]
    ds_read_b64_tr_b16 v[76:77], v220 offset:32768
    v_exp_f32 v55, v55
    v_exp_f32 v56, v56
    v_mfma_f32_16x16x32_bf16 v[28:31], v[164:167], v[184:187], v[28:31]
    ds_read_b64_tr_b16 v[78:79], v220 offset:33536
    v_exp_f32 v57, v57
    v_exp_f32 v58, v58
    v_mfma_f32_16x16x32_bf16 v[32:35], v[168:171], v[172:175], v[32:35]
    ds_read_b64_tr_b16 v[80:81], v221 offset:32768
    v_exp_f32 v59, v59
    v_exp_f32 v60, v60
    v_mfma_f32_16x16x32_bf16 v[36:39], v[168:171], v[176:179], v[36:39]
    ds_read_b64_tr_b16 v[82:83], v221 offset:33536
    v_exp_f32 v61, v61
    v_exp_f32 v62, v62
    v_mfma_f32_16x16x32_bf16 v[40:43], v[168:171], v[180:183], v[40:43]
    v_exp_f32 v63, v63
    v_add_f32 v188, v100, v102
    v_mfma_f32_16x16x32_bf16 v[44:47], v[168:171], v[184:187], v[44:47]
    v_add_f32 v190, v104, v106
    v_add_f32 v189, v101, v103
    s_waitcnt lgkmcnt(7)
    v_mfma_f32_16x16x32_bf16 v[0:3], v[72:75], v[84:87], v[0:3]
    ds_read_b64_tr_b16 v[160:161], v219 offset:38912
    v_add_f32 v191, v105, v107
    v_add_f32 v192, v108, v110
    s_waitcnt lgkmcnt(7)
    v_mfma_f32_16x16x32_bf16 v[4:7], v[72:75], v[88:91], v[4:7]
    ds_read_b64_tr_b16 v[162:163], v219 offset:39680
    v_add_f32 v194, v112, v114
    v_add_f32 v193, v109, v111
    s_waitcnt lgkmcnt(7)
    v_mfma_f32_16x16x32_bf16 v[8:11], v[72:75], v[92:95], v[8:11]
    ds_read_b128 v[172:175], v223 offset:33792
    v_add_f32 v195, v113, v115
    v_add_f32 v196, v48, v50
    s_waitcnt lgkmcnt(7)
    v_mfma_f32_16x16x32_bf16 v[12:15], v[72:75], v[96:99], v[12:15]
    ds_read_b128 v[176:179], v223 offset:35840
    v_add_f32 v198, v52, v54
    v_add_f32 v197, v49, v51
    s_waitcnt lgkmcnt(6)
    v_mfma_f32_16x16x32_bf16 v[16:19], v[76:79], v[84:87], v[16:19]
    ds_read_b128 v[180:183], v223 offset:37888
    v_add_f32 v199, v53, v55
    v_add_f32 v200, v56, v58
    v_mfma_f32_16x16x32_bf16 v[20:23], v[76:79], v[88:91], v[20:23]
    ds_read_b128 v[184:187], v223 offset:39936
    v_add_f32 v202, v60, v62
    v_add_f32 v201, v57, v59
    v_add_f32 v203, v61, v63
    v_mfma_f32_16x16x32_bf16 v[24:27], v[76:79], v[92:95], v[24:27]
    ds_read_b64_tr_b16 v[164:165], v220 offset:38912
    v_add_f32 v188, v188, v190
    v_add_f32 v189, v189, v191
    v_mfma_f32_16x16x32_bf16 v[28:31], v[76:79], v[96:99], v[28:31]
    ds_read_b64_tr_b16 v[166:167], v220 offset:39680
    v_add_f32 v192, v192, v194
    v_add_f32 v193, v193, v195
    s_waitcnt lgkmcnt(8)
    v_mfma_f32_16x16x32_bf16 v[32:35], v[80:83], v[84:87], v[32:35]
    ds_read_b64_tr_b16 v[168:169], v221 offset:38912
    v_add_f32 v196, v196, v198
    v_add_f32 v197, v197, v199
    v_mfma_f32_16x16x32_bf16 v[36:39], v[80:83], v[88:91], v[36:39]
    ds_read_b64_tr_b16 v[170:171], v221 offset:39680
    v_add_f32 v200, v200, v202
    v_add_f32 v201, v201, v203
    v_mfma_f32_16x16x32_bf16 v[40:43], v[80:83], v[92:95], v[40:43]
    v_add_f32 v128, v188, v189
    v_add_f32 v129, v192, v193
    v_mfma_f32_16x16x32_bf16 v[44:47], v[80:83], v[96:99], v[44:47]
    v_add_f32 v132, v196, v197
    v_add_f32 v133, v200, v201
    s_waitcnt lgkmcnt(7)
    v_mfma_f32_16x16x32_bf16 v[0:3], v[160:163], v[172:175], v[0:3]
    s_waitcnt lgkmcnt(0)
    s_barrier
    ds_read_b64_tr_b16 v[72:73], v216 offset:0
    v_permlane32_swap_b32 v128, v129
    v_permlane32_swap_b32 v132, v133
    v_mfma_f32_16x16x32_bf16 v[4:7], v[160:163], v[176:179], v[4:7]
    ds_read_b64_tr_b16 v[74:75], v216 offset:768
    v_add_f32 v130, v128, v129
    v_add_f32 v134, v132, v133
    v_mfma_f32_16x16x32_bf16 v[8:11], v[160:163], v[180:183], v[8:11]
    ds_read_b128 v[84:87], v222 offset:0
    v_rcp_f32 v130, v130
    v_rcp_f32 v134, v134
    v_mfma_f32_16x16x32_bf16 v[12:15], v[160:163], v[184:187], v[12:15]
    ds_read_b128 v[88:91], v222 offset:2048
    v_mov_b32 v131, v130
    v_mov_b32 v135, v134
    v_mfma_f32_16x16x32_bf16 v[16:19], v[164:167], v[172:175], v[16:19]
    ds_read_b128 v[92:95], v222 offset:4096
    v_permlane32_swap_b32 v130, v131
    v_permlane32_swap_b32 v134, v135
    v_mfma_f32_16x16x32_bf16 v[20:23], v[164:167], v[176:179], v[20:23]
    ds_read_b128 v[96:99], v222 offset:6144
    v_mul_f32 v100, v100, v130
    v_mul_f32 v101, v101, v130
    v_mfma_f32_16x16x32_bf16 v[24:27], v[164:167], v[180:183], v[24:27]
    ds_read_b64_tr_b16 v[76:77], v217 offset:0
    v_mul_f32 v102, v102, v130
    v_mul_f32 v103, v103, v130
    v_mfma_f32_16x16x32_bf16 v[28:31], v[164:167], v[184:187], v[28:31]
    ds_read_b64_tr_b16 v[78:79], v217 offset:768
    v_mul_f32 v104, v104, v130
    v_mul_f32 v105, v105, v130
    v_mfma_f32_16x16x32_bf16 v[32:35], v[168:171], v[172:175], v[32:35]
    ds_read_b64_tr_b16 v[80:81], v218 offset:0
    v_mul_f32 v106, v106, v130
    v_mul_f32 v107, v107, v130
    v_mfma_f32_16x16x32_bf16 v[36:39], v[168:171], v[176:179], v[36:39]
    ds_read_b64_tr_b16 v[82:83], v218 offset:768
    v_mul_f32 v108, v108, v131
    v_mul_f32 v109, v109, v131
    v_mfma_f32_16x16x32_bf16 v[40:43], v[168:171], v[180:183], v[40:43]
    v_mul_f32 v110, v110, v131
    v_mul_f32 v111, v111, v131
    v_mfma_f32_16x16x32_bf16 v[44:47], v[168:171], v[184:187], v[44:47]
    v_mul_f32 v112, v112, v131
    v_mul_f32 v113, v113, v131
    s_waitcnt lgkmcnt(7)
    v_mfma_f32_16x16x32_bf16 v[0:3], v[72:75], v[84:87], v[0:3]
    ds_read_b64_tr_b16 v[160:161], v216 offset:6144
    v_mul_f32 v114, v114, v131
    v_mul_f32 v115, v115, v131
    s_waitcnt lgkmcnt(7)
    v_mfma_f32_16x16x32_bf16 v[4:7], v[72:75], v[88:91], v[4:7]
    ds_read_b64_tr_b16 v[162:163], v216 offset:6912
    v_mul_f32 v48, v48, v134
    v_mul_f32 v49, v49, v134
    s_waitcnt lgkmcnt(7)
    v_mfma_f32_16x16x32_bf16 v[8:11], v[72:75], v[92:95], v[8:11]
    ds_read_b128 v[172:175], v222 offset:1024
    v_mul_f32 v50, v50, v134
    v_mul_f32 v51, v51, v134
    s_waitcnt lgkmcnt(7)
    v_mfma_f32_16x16x32_bf16 v[12:15], v[72:75], v[96:99], v[12:15]
    ds_read_b128 v[176:179], v222 offset:3072
    v_mul_f32 v52, v52, v134
    v_mul_f32 v53, v53, v134
    s_waitcnt lgkmcnt(6)
    v_mfma_f32_16x16x32_bf16 v[16:19], v[76:79], v[84:87], v[16:19]
    ds_read_b128 v[180:183], v222 offset:5120
    v_mul_f32 v54, v54, v134
    v_mul_f32 v55, v55, v134
    v_mfma_f32_16x16x32_bf16 v[20:23], v[76:79], v[88:91], v[20:23]
    ds_read_b128 v[184:187], v222 offset:7168
    v_mul_f32 v56, v56, v135
    v_mul_f32 v57, v57, v135
    v_mfma_f32_16x16x32_bf16 v[24:27], v[76:79], v[92:95], v[24:27]
    ds_read_b64_tr_b16 v[164:165], v217 offset:6144
    v_mul_f32 v58, v58, v135
    v_mul_f32 v59, v59, v135
    v_mul_f32 v60, v60, v135
    v_mfma_f32_16x16x32_bf16 v[28:31], v[76:79], v[96:99], v[28:31]
    ds_read_b64_tr_b16 v[166:167], v217 offset:6912
    v_mul_f32 v61, v61, v135
    v_mul_f32 v62, v62, v135
    s_waitcnt lgkmcnt(8)
    v_mfma_f32_16x16x32_bf16 v[32:35], v[80:83], v[84:87], v[32:35]
    ds_read_b64_tr_b16 v[168:169], v218 offset:6144
    v_mul_f32 v63, v63, v135
    v_cvt_pk_bf16_f32 v188, v100, v101
    v_mfma_f32_16x16x32_bf16 v[36:39], v[80:83], v[88:91], v[36:39]
    ds_read_b64_tr_b16 v[170:171], v218 offset:6912
    v_cvt_pk_bf16_f32 v189, v102, v103
    v_cvt_pk_bf16_f32 v190, v104, v105
    v_mfma_f32_16x16x32_bf16 v[40:43], v[80:83], v[92:95], v[40:43]
    v_cvt_pk_bf16_f32 v191, v106, v107
    v_cvt_pk_bf16_f32 v192, v108, v109
    v_mfma_f32_16x16x32_bf16 v[44:47], v[80:83], v[96:99], v[44:47]
    v_cvt_pk_bf16_f32 v193, v110, v111
    v_cvt_pk_bf16_f32 v194, v112, v113
    s_waitcnt lgkmcnt(7)
    v_mfma_f32_16x16x32_bf16 v[0:3], v[160:163], v[172:175], v[0:3]
    s_waitcnt lgkmcnt(0)
    s_barrier
    ds_read_b64_tr_b16 v[72:73], v219 offset:0
    v_cvt_pk_bf16_f32 v195, v114, v115
    v_cvt_pk_bf16_f32 v196, v48, v49
    v_mfma_f32_16x16x32_bf16 v[4:7], v[160:163], v[176:179], v[4:7]
    ds_read_b64_tr_b16 v[74:75], v219 offset:768
    v_cvt_pk_bf16_f32 v197, v50, v51
    v_cvt_pk_bf16_f32 v198, v52, v53
    v_mfma_f32_16x16x32_bf16 v[8:11], v[160:163], v[180:183], v[8:11]
    ds_read_b128 v[84:87], v223 offset:0
    v_cvt_pk_bf16_f32 v199, v54, v55
    v_cvt_pk_bf16_f32 v200, v56, v57
    v_mfma_f32_16x16x32_bf16 v[12:15], v[160:163], v[184:187], v[12:15]
    ds_read_b128 v[88:91], v223 offset:2048
    v_cvt_pk_bf16_f32 v201, v58, v59
    v_cvt_pk_bf16_f32 v202, v60, v61
    v_mfma_f32_16x16x32_bf16 v[16:19], v[164:167], v[172:175], v[16:19]
    ds_read_b128 v[92:95], v223 offset:4096
    v_cvt_pk_bf16_f32 v203, v62, v63
    v_bfe_u32 v136, v144, 4, 1
    v_mfma_f32_16x16x32_bf16 v[20:23], v[164:167], v[176:179], v[20:23]
    ds_read_b128 v[96:99], v223 offset:6144
    v_lshlrev_b32 v136, 2, v136
    v_xor_b32 v136, v136, v152
    v_mfma_f32_16x16x32_bf16 v[24:27], v[164:167], v[180:183], v[24:27]
    ds_read_b64_tr_b16 v[76:77], v220 offset:0
    v_lshlrev_b32 v136, 4, v136
    s_lshl_b32 s76, s62, 7
    v_mfma_f32_16x16x32_bf16 v[28:31], v[164:167], v[184:187], v[28:31]
    ds_read_b64_tr_b16 v[78:79], v220 offset:768
    s_lshl_b32 s77, s60, 17
    s_add_u32 s76, s76, s77
    v_mfma_f32_16x16x32_bf16 v[32:35], v[168:171], v[172:175], v[32:35]
    ds_read_b64_tr_b16 v[80:81], v221 offset:0
    v_lshl_add_u32 v232, v151, 10, v136
    v_add_u32 v232, s76, v232
    v_mfma_f32_16x16x32_bf16 v[36:39], v[168:171], v[176:179], v[36:39]
    ds_read_b64_tr_b16 v[82:83], v221 offset:768
    v_add_u32 v233, 7168, v232
    s_lshl_b32 s76, s61, 7
    v_mfma_f32_16x16x32_bf16 v[40:43], v[168:171], v[180:183], v[40:43]
    s_mul_i32 s77, s60, 1441792
    s_add_u32 s76, s76, s77
    v_mfma_f32_16x16x32_bf16 v[44:47], v[168:171], v[184:187], v[44:47]
    v_lshl_add_u32 v234, v151, 12, v136
    v_add_u32 v234, s76, v234
    s_waitcnt lgkmcnt(7)
    v_mfma_f32_16x16x32_bf16 v[0:3], v[72:75], v[84:87], v[0:3]
    ds_read_b64_tr_b16 v[160:161], v219 offset:6144
    v_add_u32 v235, 31744, v234
    v_bfe_u32 v136, v144, 3, 1
    s_waitcnt lgkmcnt(7)
    v_mfma_f32_16x16x32_bf16 v[4:7], v[72:75], v[88:91], v[4:7]
    ds_read_b64_tr_b16 v[162:163], v219 offset:6912
    v_lshlrev_b32 v136, 2, v136
    v_bfe_u32 v137, v144, 4, 1
    s_waitcnt lgkmcnt(7)
    v_mfma_f32_16x16x32_bf16 v[8:11], v[72:75], v[92:95], v[8:11]
    ds_read_b128 v[172:175], v223 offset:1024
    v_lshlrev_b32 v137, 1, v137
    v_bfe_u32 v236, v144, 1, 1
    s_waitcnt lgkmcnt(7)
    v_mfma_f32_16x16x32_bf16 v[12:15], v[72:75], v[96:99], v[12:15]
    ds_read_b128 v[176:179], v223 offset:3072
    v_add_u32 v137, v137, v236
    v_xor_b32 v137, v137, v136
    s_waitcnt lgkmcnt(6)
    v_mfma_f32_16x16x32_bf16 v[16:19], v[76:79], v[84:87], v[16:19]
    ds_read_b128 v[180:183], v223 offset:5120
    v_lshlrev_b32 v137, 4, v137
    v_and_b32 v136, 1, v144
    v_mfma_f32_16x16x32_bf16 v[20:23], v[76:79], v[88:91], v[20:23]
    ds_read_b128 v[184:187], v223 offset:7168
    v_lshl_add_u32 v137, v136, 3, v137
    v_lshl_add_u32 v136, v146, 2, v149
    v_mfma_f32_16x16x32_bf16 v[24:27], v[76:79], v[92:95], v[24:27]
    ds_read_b64_tr_b16 v[164:165], v220 offset:6144
    v_lshl_add_u32 v137, v136, 7, v137
    s_lshl_b32 s76, s60, 11
    v_mfma_f32_16x16x32_bf16 v[28:31], v[76:79], v[96:99], v[28:31]
    ds_read_b64_tr_b16 v[166:167], v220 offset:6912
    v_add_u32 v236, s76, v137
    v_xor_b32 v237, 64, v236
    s_waitcnt lgkmcnt(8)
    v_mfma_f32_16x16x32_bf16 v[32:35], v[80:83], v[84:87], v[32:35]
    ds_read_b64_tr_b16 v[168:169], v221 offset:6144
    v_add_u32 v238, 57344, v236
    v_add_u32 v239, 57344, v237
    v_add_u32 v240, 114688, v236
    v_mfma_f32_16x16x32_bf16 v[36:39], v[80:83], v[88:91], v[36:39]
    ds_read_b64_tr_b16 v[170:171], v221 offset:6912
    v_add_u32 v241, 114688, v237
    s_lshl_b32 s76, s60, 3
    v_mfma_f32_16x16x32_bf16 v[40:43], v[80:83], v[92:95], v[40:43]
    v_add_u32 v136, s76, v151
    v_lshlrev_b32 v243, 1, v136
    v_mfma_f32_16x16x32_bf16 v[44:47], v[80:83], v[96:99], v[44:47]
    v_mul_u32_u24 v244, 272, v136
    v_lshl_add_u32 v244, v152, 5, v244
    s_waitcnt lgkmcnt(7)
    v_mfma_f32_16x16x32_bf16 v[0:3], v[160:163], v[172:175], v[0:3]
    s_waitcnt lgkmcnt(0)
    s_barrier
    ds_read_b64_tr_b16 v[72:73], v216 offset:32768
    v_add_u32 v244, 81920, v244
    v_lshlrev_b32 v242, 10, v136
    v_mfma_f32_16x16x32_bf16 v[4:7], v[160:163], v[176:179], v[4:7]
    ds_read_b64_tr_b16 v[74:75], v216 offset:33536
    v_lshl_add_u32 v242, v152, 4, v242
    s_lshl_b32 s76, s61, 16
    v_mfma_f32_16x16x32_bf16 v[8:11], v[160:163], v[180:183], v[8:11]
    ds_read_b128 v[84:87], v222 offset:32768
    s_lshl_b32 s77, s62, 7
    s_add_u32 s77, s76, s77
    v_mfma_f32_16x16x32_bf16 v[12:15], v[160:163], v[184:187], v[12:15]
    ds_read_b128 v[88:91], v222 offset:34816
    v_add_u32 v242, s77, v242
    s_lshl_b32 s77, s60, 14
    v_mfma_f32_16x16x32_bf16 v[16:19], v[164:167], v[172:175], v[16:19]
    ds_read_b128 v[92:95], v222 offset:36864
    s_add_u32 s76, s76, s77
    s_add_u32 s76, s76, 14680064
    v_mfma_f32_16x16x32_bf16 v[20:23], v[164:167], v[176:179], v[20:23]
    ds_read_b128 v[96:99], v222 offset:38912
    v_add_u32 v245, s76, v157
    s_and_b32 s77, s62, 3
    v_mfma_f32_16x16x32_bf16 v[24:27], v[164:167], v[180:183], v[24:27]
    ds_read_b64_tr_b16 v[76:77], v217 offset:32768
    s_lshl_b32 s77, s77, 7
    s_add_u32 s76, s76, s77
    v_mfma_f32_16x16x32_bf16 v[28:31], v[164:167], v[184:187], v[28:31]
    ds_read_b64_tr_b16 v[78:79], v217 offset:33536
    v_lshlrev_b32 v232, 9, v145
    v_add_u32 v232, s76, v232
    v_mfma_f32_16x16x32_bf16 v[32:35], v[168:171], v[172:175], v[32:35]
    ds_read_b64_tr_b16 v[80:81], v218 offset:32768
    s_mul_i32 s76, s62, 184320
    s_mul_i32 s77, s60, 45056
    v_mfma_f32_16x16x32_bf16 v[36:39], v[168:171], v[176:179], v[36:39]
    ds_read_b64_tr_b16 v[82:83], v218 offset:33536
    s_add_u32 s76, s76, s77
    s_add_u32 s76, s76, 12582912
    v_mfma_f32_16x16x32_bf16 v[40:43], v[168:171], v[180:183], v[40:43]
    v_add_u32 v246, s76, v157
    s_and_b32 s77, s61, 7
    v_mfma_f32_16x16x32_bf16 v[44:47], v[168:171], v[184:187], v[44:47]
    s_lshl_b32 s77, s77, 7
    s_add_u32 s76, s76, s77
    s_waitcnt lgkmcnt(7)
    v_mfma_f32_16x16x32_bf16 v[0:3], v[72:75], v[84:87], v[0:3]
    ds_read_b64_tr_b16 v[160:161], v216 offset:38912
    v_min_u32 v233, 43, v144
    v_lshlrev_b32 v233, 10, v233
    s_waitcnt lgkmcnt(7)
    v_mfma_f32_16x16x32_bf16 v[4:7], v[72:75], v[88:91], v[4:7]
    ds_read_b64_tr_b16 v[162:163], v216 offset:39680
    v_add_u32 v233, s76, v233
    s_and_b32 s76, s60, 2
    s_waitcnt lgkmcnt(7)
    v_mfma_f32_16x16x32_bf16 v[8:11], v[72:75], v[92:95], v[8:11]
    ds_read_b128 v[172:175], v222 offset:33792
    s_lshl_b32 s77, s62, 2
    s_add_u32 s76, s76, s77
    s_waitcnt lgkmcnt(7)
    v_mfma_f32_16x16x32_bf16 v[12:15], v[72:75], v[96:99], v[12:15]
    ds_read_b128 v[176:179], v222 offset:35840
    s_mul_i32 s63, s76, 1088
    s_add_u32 s63, s63, 11534336
    s_waitcnt lgkmcnt(6)
    v_mfma_f32_16x16x32_bf16 v[16:19], v[76:79], v[84:87], v[16:19]
    ds_read_b128 v[180:183], v222 offset:37888
    s_lshl_b32 s77, s61, 5
    s_add_u32 s76, s76, s77
    v_mfma_f32_16x16x32_bf16 v[20:23], v[76:79], v[88:91], v[20:23]
    ds_read_b128 v[184:187], v222 offset:39936
    s_lshl_b32 s76, s76, 11
    s_and_b32 s77, s60, 1
    v_mfma_f32_16x16x32_bf16 v[24:27], v[76:79], v[92:95], v[24:27]
    ds_read_b64_tr_b16 v[164:165], v217 offset:38912
    s_lshl_b32 s77, s77, 10
    s_add_u32 s76, s76, s77
    v_mfma_f32_16x16x32_bf16 v[28:31], v[76:79], v[96:99], v[28:31]
    ds_read_b64_tr_b16 v[166:167], v217 offset:39680
    s_add_u32 s89, s76, 14680064
    v_min_u32 v247, 16, v145
    s_waitcnt lgkmcnt(8)
    v_mfma_f32_16x16x32_bf16 v[32:35], v[80:83], v[84:87], v[32:35]
    ds_read_b64_tr_b16 v[168:169], v218 offset:38912
    v_mul_u32_u24 v136, 17, v146
    v_add_lshl_u32 v247, v247, v136, 4
    v_mfma_f32_16x16x32_bf16 v[36:39], v[80:83], v[88:91], v[36:39]
    ds_read_b64_tr_b16 v[170:171], v218 offset:39680
    s_lshl_b32 s76, s13, 2
    s_add_u32 s76, s76, s12
    v_mfma_f32_16x16x32_bf16 v[40:43], v[80:83], v[92:95], v[40:43]
    s_mul_i32 s76, s76, 2560
    s_add_u32 s76, s76, 18874368
    v_mul_u32_u24 v249, 640, v150
    v_mfma_f32_16x16x32_bf16 v[44:47], v[80:83], v[96:99], v[44:47]
    v_add_u32 v249, s76, v249
    s_mul_i32 s76, s62, 81920
    s_waitcnt lgkmcnt(7)
    v_mfma_f32_16x16x32_bf16 v[0:3], v[160:163], v[172:175], v[0:3]
    s_waitcnt lgkmcnt(0)
    s_barrier
    ds_read_b64_tr_b16 v[72:73], v219 offset:32768
    s_mul_i32 s77, s60, 480612
    s_lshr_b32 s77, s77, 16
    v_mfma_f32_16x16x32_bf16 v[4:7], v[160:163], v[176:179], v[4:7]
    ds_read_b64_tr_b16 v[74:75], v219 offset:33536
    s_mul_i32 s77, s77, 640
    s_add_u32 s76, s76, s77
    v_mfma_f32_16x16x32_bf16 v[8:11], v[160:163], v[180:183], v[8:11]
    ds_read_b128 v[84:87], v223 offset:32768
    s_add_u32 s76, s76, 16777216
    v_bfe_u32 v136, v144, 3, 2
    v_mfma_f32_16x16x32_bf16 v[12:15], v[160:163], v[184:187], v[12:15]
    ds_read_b128 v[88:91], v223 offset:34816
    v_mul_u32_u24 v136, 20480, v136
    v_mul_u32_u24 v251, 640, v152
    v_mfma_f32_16x16x32_bf16 v[16:19], v[164:167], v[172:175], v[16:19]
    ds_read_b128 v[92:95], v223 offset:36864
    v_add3_u32 v250, v251, v136, s76
    s_mul_i32 s76, s61, 20480
    v_mfma_f32_16x16x32_bf16 v[20:23], v[164:167], v[176:179], v[20:23]
    ds_read_b128 v[96:99], v223 offset:38912
    s_mul_i32 s77, s60, 5120
    s_add_u32 s76, s76, s77
    v_mfma_f32_16x16x32_bf16 v[24:27], v[164:167], v[180:183], v[24:27]
    ds_read_b64_tr_b16 v[76:77], v220 offset:32768
    s_add_u32 s76, s76, 17825792
    v_add_u32 v251, s76, v251
    v_mfma_f32_16x16x32_bf16 v[28:31], v[164:167], v[184:187], v[28:31]
    ds_read_b64_tr_b16 v[78:79], v220 offset:33536
    s_mul_i32 s76, s1, 96
    v_lshlrev_b32 v252, 3, v148
    v_mfma_f32_16x16x32_bf16 v[32:35], v[168:171], v[172:175], v[32:35]
    ds_read_b64_tr_b16 v[80:81], v221 offset:32768
    v_add_u32 v252, s76, v252
    v_bfe_u32 v136, v144, 4, 1
    v_mfma_f32_16x16x32_bf16 v[36:39], v[168:171], v[176:179], v[36:39]
    ds_read_b64_tr_b16 v[82:83], v221 offset:33536
    v_lshlrev_b32 v253, 4, v147
    v_lshl_add_u32 v253, v136, 9, v253
    v_mfma_f32_16x16x32_bf16 v[40:43], v[168:171], v[180:183], v[40:43]
    v_lshl_add_u32 v253, v146, 11, v253
    s_lshr_b32 s76, s0, 2
    v_mfma_f32_16x16x32_bf16 v[44:47], v[168:171], v[184:187], v[44:47]
    s_mul_i32 s77, s76, 184320
    s_mul_i32 s76, s1, 6144
    s_waitcnt lgkmcnt(7)
    v_mfma_f32_16x16x32_bf16 v[0:3], v[72:75], v[84:87], v[0:3]
    ds_read_b64_tr_b16 v[160:161], v219 offset:38912
    s_add_u32 s77, s77, s76
    s_bfe_u32 s76, s0, 0x10001
    s_waitcnt lgkmcnt(7)
    v_mfma_f32_16x16x32_bf16 v[4:7], v[72:75], v[88:91], v[4:7]
    ds_read_b64_tr_b16 v[162:163], v219 offset:39680
    s_lshl_b32 s76, s76, 10
    s_add_u32 s77, s77, s76
    s_waitcnt lgkmcnt(7)
    v_mfma_f32_16x16x32_bf16 v[8:11], v[72:75], v[92:95], v[8:11]
    ds_read_b128 v[172:175], v223 offset:33792
    s_and_b32 s76, s0, 1
    s_lshl_b32 s76, s76, 8
    s_waitcnt lgkmcnt(7)
    v_mfma_f32_16x16x32_bf16 v[12:15], v[72:75], v[96:99], v[12:15]
    ds_read_b128 v[176:179], v223 offset:35840
    s_add_u32 s77, s77, s76
    s_add_u32 s67, s77, 12582912
    s_waitcnt lgkmcnt(6)
    v_mfma_f32_16x16x32_bf16 v[16:19], v[76:79], v[84:87], v[16:19]
    ds_read_b128 v[180:183], v223 offset:37888
    s_add_u32 s3, s67, 4096
    s_lshl_b32 s78, s13, 2
    v_mfma_f32_16x16x32_bf16 v[20:23], v[76:79], v[88:91], v[20:23]
    ds_read_b128 v[184:187], v223 offset:39936
    s_add_u32 s78, s78, s12
    s_mul_i32 s76, s78, 24576
    v_mfma_f32_16x16x32_bf16 v[24:27], v[76:79], v[92:95], v[24:27]
    ds_read_b64_tr_b16 v[164:165], v220 offset:38912
    s_add_u32 s76, s76, 2097152
    s_lshr_b32 s78, s60, 1
    v_mfma_f32_16x16x32_bf16 v[28:31], v[76:79], v[96:99], v[28:31]
    ds_read_b64_tr_b16 v[166:167], v220 offset:39680
    s_lshl_b32 s78, s78, 10
    s_add_u32 s77, s76, s78
    s_waitcnt lgkmcnt(8)
    v_mfma_f32_16x16x32_bf16 v[32:35], v[80:83], v[84:87], v[32:35]
    ds_read_b64_tr_b16 v[168:169], v221 offset:38912
    s_and_b32 s78, s60, 1
    s_lshl_b32 s78, s78, 3
    v_mfma_f32_16x16x32_bf16 v[36:39], v[80:83], v[88:91], v[36:39]
    ds_read_b64_tr_b16 v[170:171], v221 offset:39680
    s_add_u32 s77, s77, s78
    s_add_u32 s77, s77, 4096
    v_mfma_f32_16x16x32_bf16 v[40:43], v[80:83], v[92:95], v[40:43]
    s_lshl_b32 s78, s60, 10
    s_add_u32 s76, s76, s78
    v_mfma_f32_16x16x32_bf16 v[44:47], v[80:83], v[96:99], v[44:47]
    s_lshl_b32 s81, s60, 11
    s_mov_b32 s68, 0
    s_waitcnt lgkmcnt(7)
    v_mfma_f32_16x16x32_bf16 v[0:3], v[160:163], v[172:175], v[0:3]
    s_waitcnt lgkmcnt(6)
    v_mfma_f32_16x16x32_bf16 v[4:7], v[160:163], v[176:179], v[4:7]
    s_waitcnt lgkmcnt(5)
    v_mfma_f32_16x16x32_bf16 v[8:11], v[160:163], v[180:183], v[8:11]
    s_waitcnt lgkmcnt(4)
    v_mfma_f32_16x16x32_bf16 v[12:15], v[160:163], v[184:187], v[12:15]
    s_waitcnt lgkmcnt(2)
    v_mfma_f32_16x16x32_bf16 v[16:19], v[164:167], v[172:175], v[16:19]
    v_mfma_f32_16x16x32_bf16 v[20:23], v[164:167], v[176:179], v[20:23]
    v_mfma_f32_16x16x32_bf16 v[24:27], v[164:167], v[180:183], v[24:27]
    v_mfma_f32_16x16x32_bf16 v[28:31], v[164:167], v[184:187], v[28:31]
    s_waitcnt lgkmcnt(0)
    v_mfma_f32_16x16x32_bf16 v[32:35], v[168:171], v[172:175], v[32:35]
    v_mfma_f32_16x16x32_bf16 v[36:39], v[168:171], v[176:179], v[36:39]
    v_mfma_f32_16x16x32_bf16 v[40:43], v[168:171], v[180:183], v[40:43]
    v_mfma_f32_16x16x32_bf16 v[44:47], v[168:171], v[184:187], v[44:47]
    s_load_dword s4, s[24:25], 0
    s_load_dword s5, s[24:25], 32
    s_load_dword s6, s[24:25], 64
    s_load_dword s7, s[24:25], 96
    s_load_dword s8, s[24:25], 128
    s_load_dword s9, s[24:25], 160
    s_load_dword s84, s[24:25], 192
    s_load_dword s85, s[24:25], 224
    v_cvt_pk_bf16_f32 v72, v0, v1
    v_cvt_pk_bf16_f32 v73, v2, v3
    v_cvt_pk_bf16_f32 v74, v16, v17
    v_cvt_pk_bf16_f32 v75, v18, v19
    buffer_store_dwordx4 v[72:75], v157, s[40:43], s70 offen offset:0 sc1
    v_cvt_pk_bf16_f32 v76, v4, v5
    v_cvt_pk_bf16_f32 v77, v6, v7
    v_cvt_pk_bf16_f32 v78, v20, v21
    v_cvt_pk_bf16_f32 v79, v22, v23
    buffer_store_dwordx4 v[76:79], v157, s[40:43], s70 offen offset:1024 sc1
    v_cvt_pk_bf16_f32 v80, v8, v9
    v_cvt_pk_bf16_f32 v81, v10, v11
    v_cvt_pk_bf16_f32 v82, v24, v25
    v_cvt_pk_bf16_f32 v83, v26, v27
    buffer_store_dwordx4 v[80:83], v157, s[40:43], s70 offen offset:2048 sc1
    v_cvt_pk_bf16_f32 v84, v12, v13
    v_cvt_pk_bf16_f32 v85, v14, v15
    v_cvt_pk_bf16_f32 v86, v28, v29
    v_cvt_pk_bf16_f32 v87, v30, v31
    buffer_store_dwordx4 v[84:87], v157, s[40:43], s70 offen offset:3072 sc1
    v_cvt_pk_bf16_f32 v88, v32, v33
    v_cvt_pk_bf16_f32 v89, v34, v35
    v_cvt_pk_bf16_f32 v90, v36, v37
    v_cvt_pk_bf16_f32 v91, v38, v39
    v_cvt_pk_bf16_f32 v92, v40, v41
    v_cvt_pk_bf16_f32 v93, v42, v43
    v_cvt_pk_bf16_f32 v94, v44, v45
    v_cvt_pk_bf16_f32 v95, v46, v47
    buffer_store_dwordx4 v[88:91], v157, s[40:43], s71 offen offset:0 sc1
    buffer_store_dwordx4 v[92:95], v157, s[40:43], s71 offen offset:1024 sc1
    s_nop 1
    s_branch L_AFTERC
L_RED:
    v_lshlrev_b32 v159, 5, v152
    buffer_load_dword v158, v159, s[52:55], 0 offen sc1
    s_waitcnt vmcnt(0)
    v_cmp_gt_u32 vcc, 32, v158
    s_cbranch_vccz L_F1R_OK
    s_mov_b32 s80, 0
L_F1R_SPIN:
    s_sleep 4
    buffer_load_dword v158, v159, s[52:55], 0 offen sc1
    s_add_u32 s80, s80, 1
    s_cmp_gt_u32 s80, 0x20000
    s_cbranch_scc1 L_F1R_OK
    s_waitcnt vmcnt(0)
    v_cmp_gt_u32 vcc, 32, v158
    s_cbranch_vccnz L_F1R_SPIN
L_F1R_OK:
    s_lshl_b32 s66, s60, 4
    s_add_u32 s74, s83, s66
    s_cmp_ge_u32 s74, 34
    s_cbranch_scc1 L_RDONE
    s_lshl_b32 s69, s74, 10
    s_add_u32 s69, s69, 8388608
    s_mov_b32 s64, 34816
    v_mul_u32_u24 v12, s64, v145
    v_mul_u32_u24 v153, 1020, v146
    v_add_u32 v12, v12, v153
    s_mov_b32 s80, 0
    s_nop 0
L_RPOLL:
    buffer_load_dword v158, v12, s[40:43], s69 offen sc1
    s_add_u32 s80, s80, 1
    s_cmp_gt_u32 s80, 0x8000
    s_cbranch_scc1 L_RPASS
    s_waitcnt vmcnt(0)
    v_cmp_eq_u32 vcc, -1, v158
    s_cbranch_vccz L_RPASS
    s_sleep 4
    s_branch L_RPOLL
L_RPASS:
    s_waitcnt vmcnt(0)
    s_mov_b32 s75, s69
    buffer_load_dwordx4 v[16:19], v157, s[40:43], s75 offen sc1
    s_add_u32 s75, s75, 34816
    buffer_load_dwordx4 v[20:23], v157, s[40:43], s75 offen sc1
    s_add_u32 s75, s75, 34816
    buffer_load_dwordx4 v[24:27], v157, s[40:43], s75 offen sc1
    s_add_u32 s75, s75, 34816
    buffer_load_dwordx4 v[28:31], v157, s[40:43], s75 offen sc1
    s_add_u32 s75, s75, 34816
    buffer_load_dwordx4 v[32:35], v157, s[40:43], s75 offen sc1
    s_add_u32 s75, s75, 34816
    buffer_load_dwordx4 v[36:39], v157, s[40:43], s75 offen sc1
    s_add_u32 s75, s75, 34816
    buffer_load_dwordx4 v[40:43], v157, s[40:43], s75 offen sc1
    s_add_u32 s75, s75, 34816
    buffer_load_dwordx4 v[44:47], v157, s[40:43], s75 offen sc1
    s_add_u32 s75, s75, 34816
    buffer_load_dwordx4 v[72:75], v157, s[40:43], s75 offen sc1
    s_add_u32 s75, s75, 34816
    buffer_load_dwordx4 v[76:79], v157, s[40:43], s75 offen sc1
    s_add_u32 s75, s75, 34816
    buffer_load_dwordx4 v[80:83], v157, s[40:43], s75 offen sc1
    s_add_u32 s75, s75, 34816
    buffer_load_dwordx4 v[84:87], v157, s[40:43], s75 offen sc1
    s_add_u32 s75, s75, 34816
    buffer_load_dwordx4 v[88:91], v157, s[40:43], s75 offen sc1
    s_add_u32 s75, s75, 34816
    buffer_load_dwordx4 v[92:95], v157, s[40:43], s75 offen sc1
    s_add_u32 s75, s75, 34816
    buffer_load_dwordx4 v[96:99], v157, s[40:43], s75 offen sc1
    s_add_u32 s75, s75, 34816
    buffer_load_dwordx4 v[116:119], v157, s[40:43], s75 offen sc1
    s_add_u32 s75, s75, 34816
    buffer_load_dwordx4 v[120:123], v157, s[40:43], s75 offen sc1
    s_add_u32 s75, s75, 34816
    buffer_load_dwordx4 v[124:127], v157, s[40:43], s75 offen sc1
    s_add_u32 s75, s75, 34816
    buffer_load_dwordx4 v[128:131], v157, s[40:43], s75 offen sc1
    s_add_u32 s75, s75, 34816
    buffer_load_dwordx4 v[132:135], v157, s[40:43], s75 offen sc1
    s_add_u32 s75, s75, 34816
    buffer_load_dwordx4 v[160:163], v157, s[40:43], s75 offen sc1
    s_add_u32 s75, s75, 34816
    buffer_load_dwordx4 v[164:167], v157, s[40:43], s75 offen sc1
    s_add_u32 s75, s75, 34816
    buffer_load_dwordx4 v[168:171], v157, s[40:43], s75 offen sc1
    s_add_u32 s75, s75, 34816
    buffer_load_dwordx4 v[172:175], v157, s[40:43], s75 offen sc1
    s_add_u32 s75, s75, 34816
    buffer_load_dwordx4 v[176:179], v157, s[40:43], s75 offen sc1
    s_add_u32 s75, s75, 34816
    buffer_load_dwordx4 v[180:183], v157, s[40:43], s75 offen sc1
    s_add_u32 s75, s75, 34816
    buffer_load_dwordx4 v[184:187], v157, s[40:43], s75 offen sc1
    s_add_u32 s75, s75, 34816
    buffer_load_dwordx4 v[188:191], v157, s[40:43], s75 offen sc1
    s_add_u32 s75, s75, 34816
    buffer_load_dwordx4 v[192:195], v157, s[40:43], s75 offen sc1
    s_add_u32 s75, s75, 34816
    buffer_load_dwordx4 v[196:199], v157, s[40:43], s75 offen sc1
    s_add_u32 s75, s75, 34816
    buffer_load_dwordx4 v[200:203], v157, s[40:43], s75 offen sc1
    s_add_u32 s75, s75, 34816
    buffer_load_dwordx4 v[204:207], v157, s[40:43], s75 offen sc1
    s_add_u32 s75, s75, 34816
    v_mov_b32 v0, 0
    v_mov_b32 v1, 0
    v_mov_b32 v2, 0
    v_mov_b32 v3, 0
    v_mov_b32 v4, 0
    v_mov_b32 v5, 0
    v_mov_b32 v6, 0
    v_mov_b32 v7, 0
    v_mov_b32 v8, 0x3f80
    v_mov_b32 v9, 0x3f800000
    s_waitcnt vmcnt(28)
    v_dot2c_f32_bf16 v0, v8, v16
    v_dot2c_f32_bf16 v1, v9, v16
    v_dot2c_f32_bf16 v2, v8, v17
    v_dot2c_f32_bf16 v3, v9, v17
    v_dot2c_f32_bf16 v4, v8, v18
    v_dot2c_f32_bf16 v5, v9, v18
    v_dot2c_f32_bf16 v6, v8, v19
    v_dot2c_f32_bf16 v7, v9, v19
    v_dot2c_f32_bf16 v0, v8, v20
    v_dot2c_f32_bf16 v1, v9, v20
    v_dot2c_f32_bf16 v2, v8, v21
    v_dot2c_f32_bf16 v3, v9, v21
    v_dot2c_f32_bf16 v4, v8, v22
    v_dot2c_f32_bf16 v5, v9, v22
    v_dot2c_f32_bf16 v6, v8, v23
    v_dot2c_f32_bf16 v7, v9, v23
    v_dot2c_f32_bf16 v0, v8, v24
    v_dot2c_f32_bf16 v1, v9, v24
    v_dot2c_f32_bf16 v2, v8, v25
    v_dot2c_f32_bf16 v3, v9, v25
    v_dot2c_f32_bf16 v4, v8, v26
    v_dot2c_f32_bf16 v5, v9, v26
    v_dot2c_f32_bf16 v6, v8, v27
    v_dot2c_f32_bf16 v7, v9, v27
    v_dot2c_f32_bf16 v0, v8, v28
    v_dot2c_f32_bf16 v1, v9, v28
    v_dot2c_f32_bf16 v2, v8, v29
    v_dot2c_f32_bf16 v3, v9, v29
    v_dot2c_f32_bf16 v4, v8, v30
    v_dot2c_f32_bf16 v5, v9, v30
    v_dot2c_f32_bf16 v6, v8, v31
    v_dot2c_f32_bf16 v7, v9, v31
    s_waitcnt vmcnt(24)
    v_dot2c_f32_bf16 v0, v8, v32
    v_dot2c_f32_bf16 v1, v9, v32
    v_dot2c_f32_bf16 v2, v8, v33
    v_dot2c_f32_bf16 v3, v9, v33
    v_dot2c_f32_bf16 v4, v8, v34
    v_dot2c_f32_bf16 v5, v9, v34
    v_dot2c_f32_bf16 v6, v8, v35
    v_dot2c_f32_bf16 v7, v9, v35
    v_dot2c_f32_bf16 v0, v8, v36
    v_dot2c_f32_bf16 v1, v9, v36
    v_dot2c_f32_bf16 v2, v8, v37
    v_dot2c_f32_bf16 v3, v9, v37
    v_dot2c_f32_bf16 v4, v8, v38
    v_dot2c_f32_bf16 v5, v9, v38
    v_dot2c_f32_bf16 v6, v8, v39
    v_dot2c_f32_bf16 v7, v9, v39
    v_dot2c_f32_bf16 v0, v8, v40
    v_dot2c_f32_bf16 v1, v9, v40
    v_dot2c_f32_bf16 v2, v8, v41
    v_dot2c_f32_bf16 v3, v9, v41
    v_dot2c_f32_bf16 v4, v8, v42
    v_dot2c_f32_bf16 v5, v9, v42
    v_dot2c_f32_bf16 v6, v8, v43
    v_dot2c_f32_bf16 v7, v9, v43
    v_dot2c_f32_bf16 v0, v8, v44
    v_dot2c_f32_bf16 v1, v9, v44
    v_dot2c_f32_bf16 v2, v8, v45
    v_dot2c_f32_bf16 v3, v9, v45
    v_dot2c_f32_bf16 v4, v8, v46
    v_dot2c_f32_bf16 v5, v9, v46
    v_dot2c_f32_bf16 v6, v8, v47
    v_dot2c_f32_bf16 v7, v9, v47
    s_waitcnt vmcnt(20)
    v_dot2c_f32_bf16 v0, v8, v72
    v_dot2c_f32_bf16 v1, v9, v72
    v_dot2c_f32_bf16 v2, v8, v73
    v_dot2c_f32_bf16 v3, v9, v73
    v_dot2c_f32_bf16 v4, v8, v74
    v_dot2c_f32_bf16 v5, v9, v74
    v_dot2c_f32_bf16 v6, v8, v75
    v_dot2c_f32_bf16 v7, v9, v75
    v_dot2c_f32_bf16 v0, v8, v76
    v_dot2c_f32_bf16 v1, v9, v76
    v_dot2c_f32_bf16 v2, v8, v77
    v_dot2c_f32_bf16 v3, v9, v77
    v_dot2c_f32_bf16 v4, v8, v78
    v_dot2c_f32_bf16 v5, v9, v78
    v_dot2c_f32_bf16 v6, v8, v79
    v_dot2c_f32_bf16 v7, v9, v79
    v_dot2c_f32_bf16 v0, v8, v80
    v_dot2c_f32_bf16 v1, v9, v80
    v_dot2c_f32_bf16 v2, v8, v81
    v_dot2c_f32_bf16 v3, v9, v81
    v_dot2c_f32_bf16 v4, v8, v82
    v_dot2c_f32_bf16 v5, v9, v82
    v_dot2c_f32_bf16 v6, v8, v83
    v_dot2c_f32_bf16 v7, v9, v83
    v_dot2c_f32_bf16 v0, v8, v84
    v_dot2c_f32_bf16 v1, v9, v84
    v_dot2c_f32_bf16 v2, v8, v85
    v_dot2c_f32_bf16 v3, v9, v85
    v_dot2c_f32_bf16 v4, v8, v86
    v_dot2c_f32_bf16 v5, v9, v86
    v_dot2c_f32_bf16 v6, v8, v87
    v_dot2c_f32_bf16 v7, v9, v87
    s_waitcnt vmcnt(16)
    v_dot2c_f32_bf16 v0, v8, v88
    v_dot2c_f32_bf16 v1, v9, v88
    v_dot2c_f32_bf16 v2, v8, v89
    v_dot2c_f32_bf16 v3, v9, v89
    v_dot2c_f32_bf16 v4, v8, v90
    v_dot2c_f32_bf16 v5, v9, v90
    v_dot2c_f32_bf16 v6, v8, v91
    v_dot2c_f32_bf16 v7, v9, v91
    v_dot2c_f32_bf16 v0, v8, v92
    v_dot2c_f32_bf16 v1, v9, v92
    v_dot2c_f32_bf16 v2, v8, v93
    v_dot2c_f32_bf16 v3, v9, v93
    v_dot2c_f32_bf16 v4, v8, v94
    v_dot2c_f32_bf16 v5, v9, v94
    v_dot2c_f32_bf16 v6, v8, v95
    v_dot2c_f32_bf16 v7, v9, v95
    v_dot2c_f32_bf16 v0, v8, v96
    v_dot2c_f32_bf16 v1, v9, v96
    v_dot2c_f32_bf16 v2, v8, v97
    v_dot2c_f32_bf16 v3, v9, v97
    v_dot2c_f32_bf16 v4, v8, v98
    v_dot2c_f32_bf16 v5, v9, v98
    v_dot2c_f32_bf16 v6, v8, v99
    v_dot2c_f32_bf16 v7, v9, v99
    v_dot2c_f32_bf16 v0, v8, v116
    v_dot2c_f32_bf16 v1, v9, v116
    v_dot2c_f32_bf16 v2, v8, v117
    v_dot2c_f32_bf16 v3, v9, v117
    v_dot2c_f32_bf16 v4, v8, v118
    v_dot2c_f32_bf16 v5, v9, v118
    v_dot2c_f32_bf16 v6, v8, v119
    v_dot2c_f32_bf16 v7, v9, v119
    s_waitcnt vmcnt(12)
    v_dot2c_f32_bf16 v0, v8, v120
    v_dot2c_f32_bf16 v1, v9, v120
    v_dot2c_f32_bf16 v2, v8, v121
    v_dot2c_f32_bf16 v3, v9, v121
    v_dot2c_f32_bf16 v4, v8, v122
    v_dot2c_f32_bf16 v5, v9, v122
    v_dot2c_f32_bf16 v6, v8, v123
    v_dot2c_f32_bf16 v7, v9, v123
    v_dot2c_f32_bf16 v0, v8, v124
    v_dot2c_f32_bf16 v1, v9, v124
    v_dot2c_f32_bf16 v2, v8, v125
    v_dot2c_f32_bf16 v3, v9, v125
    v_dot2c_f32_bf16 v4, v8, v126
    v_dot2c_f32_bf16 v5, v9, v126
    v_dot2c_f32_bf16 v6, v8, v127
    v_dot2c_f32_bf16 v7, v9, v127
    v_dot2c_f32_bf16 v0, v8, v128
    v_dot2c_f32_bf16 v1, v9, v128
    v_dot2c_f32_bf16 v2, v8, v129
    v_dot2c_f32_bf16 v3, v9, v129
    v_dot2c_f32_bf16 v4, v8, v130
    v_dot2c_f32_bf16 v5, v9, v130
    v_dot2c_f32_bf16 v6, v8, v131
    v_dot2c_f32_bf16 v7, v9, v131
    v_dot2c_f32_bf16 v0, v8, v132
    v_dot2c_f32_bf16 v1, v9, v132
    v_dot2c_f32_bf16 v2, v8, v133
    v_dot2c_f32_bf16 v3, v9, v133
    v_dot2c_f32_bf16 v4, v8, v134
    v_dot2c_f32_bf16 v5, v9, v134
    v_dot2c_f32_bf16 v6, v8, v135
    v_dot2c_f32_bf16 v7, v9, v135
    s_waitcnt vmcnt(8)
    v_dot2c_f32_bf16 v0, v8, v160
    v_dot2c_f32_bf16 v1, v9, v160
    v_dot2c_f32_bf16 v2, v8, v161
    v_dot2c_f32_bf16 v3, v9, v161
    v_dot2c_f32_bf16 v4, v8, v162
    v_dot2c_f32_bf16 v5, v9, v162
    v_dot2c_f32_bf16 v6, v8, v163
    v_dot2c_f32_bf16 v7, v9, v163
    v_dot2c_f32_bf16 v0, v8, v164
    v_dot2c_f32_bf16 v1, v9, v164
    v_dot2c_f32_bf16 v2, v8, v165
    v_dot2c_f32_bf16 v3, v9, v165
    v_dot2c_f32_bf16 v4, v8, v166
    v_dot2c_f32_bf16 v5, v9, v166
    v_dot2c_f32_bf16 v6, v8, v167
    v_dot2c_f32_bf16 v7, v9, v167
    v_dot2c_f32_bf16 v0, v8, v168
    v_dot2c_f32_bf16 v1, v9, v168
    v_dot2c_f32_bf16 v2, v8, v169
    v_dot2c_f32_bf16 v3, v9, v169
    v_dot2c_f32_bf16 v4, v8, v170
    v_dot2c_f32_bf16 v5, v9, v170
    v_dot2c_f32_bf16 v6, v8, v171
    v_dot2c_f32_bf16 v7, v9, v171
    v_dot2c_f32_bf16 v0, v8, v172
    v_dot2c_f32_bf16 v1, v9, v172
    v_dot2c_f32_bf16 v2, v8, v173
    v_dot2c_f32_bf16 v3, v9, v173
    v_dot2c_f32_bf16 v4, v8, v174
    v_dot2c_f32_bf16 v5, v9, v174
    v_dot2c_f32_bf16 v6, v8, v175
    v_dot2c_f32_bf16 v7, v9, v175
    s_waitcnt vmcnt(4)
    v_dot2c_f32_bf16 v0, v8, v176
    v_dot2c_f32_bf16 v1, v9, v176
    v_dot2c_f32_bf16 v2, v8, v177
    v_dot2c_f32_bf16 v3, v9, v177
    v_dot2c_f32_bf16 v4, v8, v178
    v_dot2c_f32_bf16 v5, v9, v178
    v_dot2c_f32_bf16 v6, v8, v179
    v_dot2c_f32_bf16 v7, v9, v179
    v_dot2c_f32_bf16 v0, v8, v180
    v_dot2c_f32_bf16 v1, v9, v180
    v_dot2c_f32_bf16 v2, v8, v181
    v_dot2c_f32_bf16 v3, v9, v181
    v_dot2c_f32_bf16 v4, v8, v182
    v_dot2c_f32_bf16 v5, v9, v182
    v_dot2c_f32_bf16 v6, v8, v183
    v_dot2c_f32_bf16 v7, v9, v183
    v_dot2c_f32_bf16 v0, v8, v184
    v_dot2c_f32_bf16 v1, v9, v184
    v_dot2c_f32_bf16 v2, v8, v185
    v_dot2c_f32_bf16 v3, v9, v185
    v_dot2c_f32_bf16 v4, v8, v186
    v_dot2c_f32_bf16 v5, v9, v186
    v_dot2c_f32_bf16 v6, v8, v187
    v_dot2c_f32_bf16 v7, v9, v187
    v_dot2c_f32_bf16 v0, v8, v188
    v_dot2c_f32_bf16 v1, v9, v188
    v_dot2c_f32_bf16 v2, v8, v189
    v_dot2c_f32_bf16 v3, v9, v189
    v_dot2c_f32_bf16 v4, v8, v190
    v_dot2c_f32_bf16 v5, v9, v190
    v_dot2c_f32_bf16 v6, v8, v191
    v_dot2c_f32_bf16 v7, v9, v191
    s_waitcnt vmcnt(0)
    v_dot2c_f32_bf16 v0, v8, v192
    v_dot2c_f32_bf16 v1, v9, v192
    v_dot2c_f32_bf16 v2, v8, v193
    v_dot2c_f32_bf16 v3, v9, v193
    v_dot2c_f32_bf16 v4, v8, v194
    v_dot2c_f32_bf16 v5, v9, v194
    v_dot2c_f32_bf16 v6, v8, v195
    v_dot2c_f32_bf16 v7, v9, v195
    v_dot2c_f32_bf16 v0, v8, v196
    v_dot2c_f32_bf16 v1, v9, v196
    v_dot2c_f32_bf16 v2, v8, v197
    v_dot2c_f32_bf16 v3, v9, v197
    v_dot2c_f32_bf16 v4, v8, v198
    v_dot2c_f32_bf16 v5, v9, v198
    v_dot2c_f32_bf16 v6, v8, v199
    v_dot2c_f32_bf16 v7, v9, v199
    v_dot2c_f32_bf16 v0, v8, v200
    v_dot2c_f32_bf16 v1, v9, v200
    v_dot2c_f32_bf16 v2, v8, v201
    v_dot2c_f32_bf16 v3, v9, v201
    v_dot2c_f32_bf16 v4, v8, v202
    v_dot2c_f32_bf16 v5, v9, v202
    v_dot2c_f32_bf16 v6, v8, v203
    v_dot2c_f32_bf16 v7, v9, v203
    v_dot2c_f32_bf16 v0, v8, v204
    v_dot2c_f32_bf16 v1, v9, v204
    v_dot2c_f32_bf16 v2, v8, v205
    v_dot2c_f32_bf16 v3, v9, v205
    v_dot2c_f32_bf16 v4, v8, v206
    v_dot2c_f32_bf16 v5, v9, v206
    v_dot2c_f32_bf16 v6, v8, v207
    v_dot2c_f32_bf16 v7, v9, v207
    v_add_f32 v10, v0, v2
    s_nop 0
    v_add_f32 v11, v4, v6
    v_cmp_u_f32 vcc, v10, v11
    s_nop 0
    s_cbranch_vccz L_RGOOD
    s_add_u32 s80, s80, 0x400
    s_cmp_gt_u32 s80, 0x8000
    s_cbranch_scc0 L_RPASS
L_RGOOD:
    v_cvt_pk_bf16_f32 v88, v0, v1
    v_cvt_pk_bf16_f32 v89, v2, v3
    v_cvt_pk_bf16_f32 v90, v4, v5
    v_cvt_pk_bf16_f32 v91, v6, v7
    s_lshl_b32 s65, s74, 10
    s_add_u32 s65, s65, 11534336
    buffer_store_dwordx4 v[88:91], v157, s[40:43], s65 offen sc1
    s_nop 1
L_RDONE:
    v_fma_f32 v48, -v228, v100, v48
    v_fma_f32 v49, -v228, v101, v49
    v_fma_f32 v50, -v228, v102, v50
    v_fma_f32 v51, -v228, v103, v51
    v_fma_f32 v52, -v228, v104, v52
    v_fma_f32 v53, -v228, v105, v53
    v_fma_f32 v54, -v228, v106, v54
    v_fma_f32 v55, -v228, v107, v55
    v_fma_f32 v56, -v228, v108, v56
    v_fma_f32 v57, -v228, v109, v57
    v_fma_f32 v58, -v228, v110, v58
    v_fma_f32 v59, -v228, v111, v59
    v_fma_f32 v60, -v228, v112, v60
    v_fma_f32 v61, -v228, v113, v61
    v_fma_f32 v62, -v228, v114, v62
    v_fma_f32 v63, -v228, v115, v63
    v_mul_f32 v48, v48, v229
    v_mul_f32 v49, v49, v229
    v_mul_f32 v50, v50, v229
    v_mul_f32 v51, v51, v229
    v_mul_f32 v52, v52, v229
    v_mul_f32 v53, v53, v229
    v_mul_f32 v54, v54, v229
    v_mul_f32 v55, v55, v229
    v_mul_f32 v56, v56, v229
    v_mul_f32 v57, v57, v229
    v_mul_f32 v58, v58, v229
    v_mul_f32 v59, v59, v229
    v_mul_f32 v60, v60, v229
    v_mul_f32 v61, v61, v229
    v_mul_f32 v62, v62, v229
    v_mul_f32 v63, v63, v229
    v_cvt_pk_bf16_f32 v116, v48, v49
    v_cvt_pk_bf16_f32 v117, v50, v51
    v_cvt_pk_bf16_f32 v118, v52, v53
    v_cvt_pk_bf16_f32 v119, v54, v55
    v_cvt_pk_bf16_f32 v120, v56, v57
    v_cvt_pk_bf16_f32 v121, v58, v59
    v_cvt_pk_bf16_f32 v122, v60, v61
    v_cvt_pk_bf16_f32 v123, v62, v63
    v_mfma_f32_32x32x16_bf16 v[100:115], v[208:211], v[116:119], 0
    s_nop 0
    v_mfma_f32_32x32x16_bf16 v[48:63], v[212:215], v[120:123], 0
    s_mov_b32 s32, s10
    s_mov_b32 s33, s11
    s_mov_b32 s34, 524288
    s_mov_b32 s35, 0x20000
    s_mov_b32 s56, s18
    s_mov_b32 s57, s19
    s_mov_b32 s58, 5636096
    s_mov_b32 s59, 0x20000
    s_mov_b32 s44, s16
    s_mov_b32 s45, s17
    s_mov_b32 s46, 2752
    s_mov_b32 s47, 0x20000
    v_max3_f32 v128, v100, v101, v102
    v_max3_f32 v129, v108, v109, v110
    v_max3_f32 v132, v48, v49, v50
    v_max3_f32 v133, v56, v57, v58
    v_max3_f32 v128, v128, v103, v104
    v_max3_f32 v129, v129, v111, v112
    v_max3_f32 v132, v132, v51, v52
    v_max3_f32 v133, v133, v59, v60
    v_max3_f32 v128, v128, v105, v106
    v_max3_f32 v129, v129, v113, v114
    v_max3_f32 v132, v132, v53, v54
    v_max3_f32 v133, v133, v61, v62
    v_max_f32 v128, v128, v107
    v_max_f32 v129, v129, v115
    v_max_f32 v132, v132, v55
    v_max_f32 v133, v133, v63
    v_permlane32_swap_b32 v128, v129
    s_nop 0
    v_permlane32_swap_b32 v132, v133
    v_max_f32 v130, v128, v129
    v_max_f32 v134, v132, v133
    v_mul_f32 v130, s79, v130
    v_mul_f32 v134, s79, v134
    v_mov_b32 v131, v130
    v_mov_b32 v135, v134
    s_nop 0
    v_permlane32_swap_b32 v130, v131
    v_permlane32_swap_b32 v134, v135
    v_fma_f32 v100, v100, s79, -v130
    v_fma_f32 v101, v101, s79, -v130
    v_fma_f32 v102, v102, s79, -v130
    v_fma_f32 v103, v103, s79, -v130
    v_fma_f32 v104, v104, s79, -v130
    v_fma_f32 v105, v105, s79, -v130
    v_fma_f32 v106, v106, s79, -v130
    v_fma_f32 v107, v107, s79, -v130
    v_fma_f32 v108, v108, s79, -v131
    v_fma_f32 v109, v109, s79, -v131
    v_fma_f32 v110, v110, s79, -v131
    v_fma_f32 v111, v111, s79, -v131
    v_fma_f32 v112, v112, s79, -v131
    v_fma_f32 v113, v113, s79, -v131
    v_fma_f32 v114, v114, s79, -v131
    v_fma_f32 v115, v115, s79, -v131
    v_fma_f32 v48, v48, s79, -v134
    v_fma_f32 v49, v49, s79, -v134
    v_fma_f32 v50, v50, s79, -v134
    v_fma_f32 v51, v51, s79, -v134
    v_fma_f32 v52, v52, s79, -v134
    v_fma_f32 v53, v53, s79, -v134
    v_fma_f32 v54, v54, s79, -v134
    v_fma_f32 v55, v55, s79, -v134
    v_fma_f32 v56, v56, s79, -v135
    v_fma_f32 v57, v57, s79, -v135
    v_fma_f32 v58, v58, s79, -v135
    v_fma_f32 v59, v59, s79, -v135
    v_fma_f32 v60, v60, s79, -v135
    v_fma_f32 v61, v61, s79, -v135
    v_fma_f32 v62, v62, s79, -v135
    v_fma_f32 v63, v63, s79, -v135
    v_exp_f32 v100, v100
    v_exp_f32 v101, v101
    v_exp_f32 v102, v102
    v_exp_f32 v103, v103
    v_exp_f32 v104, v104
    v_exp_f32 v105, v105
    v_exp_f32 v106, v106
    v_exp_f32 v107, v107
    v_exp_f32 v108, v108
    v_exp_f32 v109, v109
    v_exp_f32 v110, v110
    v_exp_f32 v111, v111
    v_exp_f32 v112, v112
    v_exp_f32 v113, v113
    v_exp_f32 v114, v114
    v_exp_f32 v115, v115
    v_exp_f32 v48, v48
    v_exp_f32 v49, v49
    v_exp_f32 v50, v50
    v_exp_f32 v51, v51
    v_exp_f32 v52, v52
    v_exp_f32 v53, v53
    v_exp_f32 v54, v54
    v_exp_f32 v55, v55
    v_exp_f32 v56, v56
    v_exp_f32 v57, v57
    v_exp_f32 v58, v58
    v_exp_f32 v59, v59
    v_exp_f32 v60, v60
    v_exp_f32 v61, v61
    v_exp_f32 v62, v62
    v_exp_f32 v63, v63
    v_pk_add_f32 v[188:189], v[100:101], v[102:103]
    v_pk_add_f32 v[190:191], v[104:105], v[106:107]
    v_pk_add_f32 v[192:193], v[108:109], v[110:111]
    v_pk_add_f32 v[194:195], v[112:113], v[114:115]
    v_pk_add_f32 v[196:197], v[48:49], v[50:51]
    v_pk_add_f32 v[198:199], v[52:53], v[54:55]
    v_pk_add_f32 v[200:201], v[56:57], v[58:59]
    v_pk_add_f32 v[202:203], v[60:61], v[62:63]
    v_pk_add_f32 v[188:189], v[188:189], v[190:191]
    v_pk_add_f32 v[192:193], v[192:193], v[194:195]
    v_pk_add_f32 v[196:197], v[196:197], v[198:199]
    v_pk_add_f32 v[200:201], v[200:201], v[202:203]
    v_add_f32 v128, v188, v189
    v_add_f32 v129, v192, v193
    v_add_f32 v132, v196, v197
    v_add_f32 v133, v200, v201
    v_permlane32_swap_b32 v128, v129
    s_nop 0
    v_permlane32_swap_b32 v132, v133
    v_add_f32 v130, v128, v129
    v_add_f32 v134, v132, v133
    v_rcp_f32 v130, v130
    v_rcp_f32 v134, v134
    v_mov_b32 v131, v130
    v_mov_b32 v135, v134
    s_nop 0
    v_permlane32_swap_b32 v130, v131
    v_permlane32_swap_b32 v134, v135
    v_pk_mul_f32 v[100:101], v[100:101], v[130:131] op_sel:[0,0] op_sel_hi:[1,0]
    v_pk_mul_f32 v[102:103], v[102:103], v[130:131] op_sel:[0,0] op_sel_hi:[1,0]
    v_pk_mul_f32 v[104:105], v[104:105], v[130:131] op_sel:[0,0] op_sel_hi:[1,0]
    v_pk_mul_f32 v[106:107], v[106:107], v[130:131] op_sel:[0,0] op_sel_hi:[1,0]
    v_pk_mul_f32 v[108:109], v[108:109], v[130:131] op_sel:[0,1] op_sel_hi:[1,1]
    v_pk_mul_f32 v[110:111], v[110:111], v[130:131] op_sel:[0,1] op_sel_hi:[1,1]
    v_pk_mul_f32 v[112:113], v[112:113], v[130:131] op_sel:[0,1] op_sel_hi:[1,1]
    v_pk_mul_f32 v[114:115], v[114:115], v[130:131] op_sel:[0,1] op_sel_hi:[1,1]
    v_pk_mul_f32 v[48:49], v[48:49], v[134:135] op_sel:[0,0] op_sel_hi:[1,0]
    v_pk_mul_f32 v[50:51], v[50:51], v[134:135] op_sel:[0,0] op_sel_hi:[1,0]
    v_pk_mul_f32 v[52:53], v[52:53], v[134:135] op_sel:[0,0] op_sel_hi:[1,0]
    v_pk_mul_f32 v[54:55], v[54:55], v[134:135] op_sel:[0,0] op_sel_hi:[1,0]
    v_pk_mul_f32 v[56:57], v[56:57], v[134:135] op_sel:[0,1] op_sel_hi:[1,1]
    v_pk_mul_f32 v[58:59], v[58:59], v[134:135] op_sel:[0,1] op_sel_hi:[1,1]
    v_pk_mul_f32 v[60:61], v[60:61], v[134:135] op_sel:[0,1] op_sel_hi:[1,1]
    v_pk_mul_f32 v[62:63], v[62:63], v[134:135] op_sel:[0,1] op_sel_hi:[1,1]
    v_cvt_pk_bf16_f32 v188, v100, v101
    v_cvt_pk_bf16_f32 v189, v102, v103
    v_cvt_pk_bf16_f32 v190, v104, v105
    v_cvt_pk_bf16_f32 v191, v106, v107
    v_cvt_pk_bf16_f32 v192, v108, v109
    v_cvt_pk_bf16_f32 v193, v110, v111
    v_cvt_pk_bf16_f32 v194, v112, v113
    v_cvt_pk_bf16_f32 v195, v114, v115
    v_cvt_pk_bf16_f32 v196, v48, v49
    v_cvt_pk_bf16_f32 v197, v50, v51
    v_cvt_pk_bf16_f32 v198, v52, v53
    v_cvt_pk_bf16_f32 v199, v54, v55
    v_cvt_pk_bf16_f32 v200, v56, v57
    v_cvt_pk_bf16_f32 v201, v58, v59
    v_cvt_pk_bf16_f32 v202, v60, v61
    v_cvt_pk_bf16_f32 v203, v62, v63
    v_bfe_u32 v136, v144, 4, 1
    v_lshlrev_b32 v136, 2, v136
    v_xor_b32 v136, v136, v152
    v_lshlrev_b32 v136, 4, v136
    s_lshl_b32 s76, s62, 7
    s_lshl_b32 s77, s60, 17
    s_add_u32 s76, s76, s77
    v_lshl_add_u32 v232, v151, 10, v136
    v_add_u32 v232, s76, v232
    v_add_u32 v233, 7168, v232
    s_lshl_b32 s76, s61, 7
    s_mul_i32 s77, s60, 1441792
    s_add_u32 s76, s76, s77
    v_lshl_add_u32 v234, v151, 12, v136
    v_add_u32 v234, s76, v234
    v_add_u32 v235, 31744, v234
    v_bfe_u32 v136, v144, 3, 1
    v_lshlrev_b32 v136, 2, v136
    v_bfe_u32 v137, v144, 4, 1
    v_lshlrev_b32 v137, 1, v137
    v_bfe_u32 v236, v144, 1, 1
    v_add_u32 v137, v137, v236
    v_xor_b32 v137, v137, v136
    v_lshlrev_b32 v137, 4, v137
    v_and_b32 v136, 1, v144
    v_lshl_add_u32 v137, v136, 3, v137
    v_lshl_add_u32 v136, v146, 2, v149
    v_lshl_add_u32 v137, v136, 7, v137
    s_lshl_b32 s76, s60, 11
    v_add_u32 v236, s76, v137
    v_xor_b32 v237, 64, v236
    v_add_u32 v238, 57344, v236
    v_add_u32 v239, 57344, v237
    v_add_u32 v240, 114688, v236
    v_add_u32 v241, 114688, v237
    s_lshl_b32 s76, s60, 3
    v_add_u32 v136, s76, v151
    v_lshlrev_b32 v243, 1, v136
    v_mul_u32_u24 v244, 272, v136
    v_lshl_add_u32 v244, v152, 5, v244
    v_add_u32 v244, 81920, v244
    v_lshlrev_b32 v242, 10, v136
    v_lshl_add_u32 v242, v152, 4, v242
    s_lshl_b32 s76, s61, 16
    s_lshl_b32 s77, s62, 7
    s_add_u32 s77, s76, s77
    v_add_u32 v242, s77, v242
    s_lshl_b32 s77, s60, 14
    s_add_u32 s76, s76, s77
    s_add_u32 s76, s76, 14680064
    v_add_u32 v245, s76, v157
    s_and_b32 s77, s62, 3
    s_lshl_b32 s77, s77, 7
    s_add_u32 s76, s76, s77
    v_lshlrev_b32 v232, 9, v145
    v_add_u32 v232, s76, v232
    s_mul_i32 s76, s62, 184320
    s_mul_i32 s77, s60, 45056
    s_add_u32 s76, s76, s77
    s_add_u32 s76, s76, 12582912
    v_add_u32 v246, s76, v157
    s_and_b32 s77, s61, 7
    s_lshl_b32 s77, s77, 7
    s_add_u32 s76, s76, s77
    v_min_u32 v233, 43, v144
    v_lshlrev_b32 v233, 10, v233
    v_add_u32 v233, s76, v233
    s_and_b32 s76, s60, 2
    s_lshl_b32 s77, s62, 2
    s_add_u32 s76, s76, s77
    s_mul_i32 s63, s76, 1088
    s_add_u32 s63, s63, 11534336
    s_lshl_b32 s77, s61, 5
    s_add_u32 s76, s76, s77
    s_lshl_b32 s76, s76, 11
    s_and_b32 s77, s60, 1
    s_lshl_b32 s77, s77, 10
    s_add_u32 s76, s76, s77
    s_add_u32 s89, s76, 14680064
    v_min_u32 v247, 16, v145
    v_mul_u32_u24 v136, 17, v146
    v_add_lshl_u32 v247, v247, v136, 4
    s_lshl_b32 s76, s13, 2
    s_add_u32 s76, s76, s12
    s_mul_i32 s76, s76, 2560
    s_add_u32 s76, s76, 18874368
    v_mul_u32_u24 v249, 640, v150
    v_add_u32 v249, s76, v249
    s_mul_i32 s76, s62, 81920
    s_mul_i32 s77, s60, 480612
    s_lshr_b32 s77, s77, 16
    s_mul_i32 s77, s77, 640
    s_add_u32 s76, s76, s77
    s_add_u32 s76, s76, 16777216
    v_bfe_u32 v136, v144, 3, 2
    v_mul_u32_u24 v136, 20480, v136
    v_mul_u32_u24 v251, 640, v152
    v_add3_u32 v250, v251, v136, s76
    s_mul_i32 s76, s61, 20480
    s_mul_i32 s77, s60, 5120
    s_add_u32 s76, s76, s77
    s_add_u32 s76, s76, 17825792
    v_add_u32 v251, s76, v251
    s_mul_i32 s76, s1, 96
    v_lshlrev_b32 v252, 3, v148
    v_add_u32 v252, s76, v252
    v_bfe_u32 v136, v144, 4, 1
    v_lshlrev_b32 v253, 4, v147
    v_lshl_add_u32 v253, v136, 9, v253
    v_lshl_add_u32 v253, v146, 11, v253
    s_lshr_b32 s76, s0, 2
    s_mul_i32 s77, s76, 184320
    s_mul_i32 s76, s1, 6144
    s_add_u32 s77, s77, s76
    s_bfe_u32 s76, s0, 0x10001
    s_lshl_b32 s76, s76, 10
    s_add_u32 s77, s77, s76
    s_and_b32 s76, s0, 1
    s_lshl_b32 s76, s76, 8
    s_add_u32 s77, s77, s76
    s_add_u32 s67, s77, 12582912
    s_add_u32 s3, s67, 4096
    s_lshl_b32 s78, s13, 2
    s_add_u32 s78, s78, s12
    s_mul_i32 s76, s78, 24576
    s_add_u32 s76, s76, 2097152
    s_lshr_b32 s78, s60, 1
    s_lshl_b32 s78, s78, 10
    s_add_u32 s77, s76, s78
    s_and_b32 s78, s60, 1
    s_lshl_b32 s78, s78, 3
    s_add_u32 s77, s77, s78
    s_add_u32 s77, s77, 4096
    s_lshl_b32 s78, s60, 10
    s_add_u32 s76, s76, s78
    s_lshl_b32 s81, s60, 11
    s_mov_b32 s68, 0
    s_load_dword s4, s[24:25], 0
    s_load_dword s5, s[24:25], 32
    s_load_dword s6, s[24:25], 64
    s_load_dword s7, s[24:25], 96
    s_load_dword s8, s[24:25], 128
    s_load_dword s9, s[24:25], 160
    s_load_dword s84, s[24:25], 192
    s_load_dword s85, s[24:25], 224
L_AFTERC:
    s_waitcnt lgkmcnt(0)
    s_min_u32 s4, s4, s5
    s_min_u32 s4, s4, s6
    s_min_u32 s4, s4, s7
    s_min_u32 s4, s4, s8
    s_min_u32 s4, s4, s9
    s_min_u32 s4, s4, s84
    s_min_u32 s4, s4, s85
    s_cmp_ge_u32 s4, 32
    s_cbranch_scc1 L_F1B_B
    v_lshlrev_b32 v159, 5, v152
    buffer_load_dword v158, v159, s[52:55], 0 offen sc1
    s_waitcnt vmcnt(0)
    v_cmp_gt_u32 vcc, 32, v158
    s_cbranch_vccz L_F1B_OK
    s_mov_b32 s80, 0
L_F1B_SPIN:
    s_sleep 4
    buffer_load_dword v158, v159, s[52:55], 0 offen sc1
    s_add_u32 s80, s80, 1
    s_cmp_gt_u32 s80, 0x20000
    s_cbranch_scc1 L_F1B_OK
    s_waitcnt vmcnt(0)
    v_cmp_gt_u32 vcc, 32, v158
    s_cbranch_vccnz L_F1B_SPIN
L_F1B_OK:
L_F1B_B:
    buffer_load_dwordx4 v[48:51], v247, s[40:43], s63 offen offset:0 sc1
    buffer_load_dwordx4 v[52:55], v247, s[40:43], s63 offen offset:544 sc1
    buffer_load_dwordx4 v[56:59], v247, s[40:43], s63 offen offset:1088 sc1
    buffer_load_dwordx4 v[60:63], v247, s[40:43], s63 offen offset:1632 sc1
    s_waitcnt vmcnt(4)
    v_mov_b32 v158, 0
    s_mov_b64 exec, 8
    buffer_store_dword v158, v248, s[40:43], 0 offen sc1
    s_mov_b64 exec, -1
    s_waitcnt vmcnt(1)
    v_max3_u32 v153, v48, v49, v50
    v_max3_u32 v154, v51, v52, v53
    v_max3_u32 v153, v153, v54, v55
    v_max3_u32 v154, v154, v56, v57
    v_max3_u32 v153, v153, v58, v59
    v_max3_u32 v154, v154, v60, v61
    v_max3_u32 v153, v153, v62, v63
    v_max_u32 v153, v153, v154
    v_cmp_eq_u32 vcc, -1, v153
    s_mov_b32 s80, 0
    s_cbranch_vccz L_OB_OK
L_OB:
    buffer_load_dwordx4 v[48:51], v247, s[40:43], s63 offen offset:0 sc1
    buffer_load_dwordx4 v[52:55], v247, s[40:43], s63 offen offset:544 sc1
    buffer_load_dwordx4 v[56:59], v247, s[40:43], s63 offen offset:1088 sc1
    buffer_load_dwordx4 v[60:63], v247, s[40:43], s63 offen offset:1632 sc1
    s_add_u32 s80, s80, 1
    s_waitcnt vmcnt(0)
    v_max3_u32 v153, v48, v49, v50
    v_max3_u32 v154, v51, v52, v53
    v_max3_u32 v153, v153, v54, v55
    v_max3_u32 v154, v154, v56, v57
    v_max3_u32 v153, v153, v58, v59
    v_max3_u32 v154, v154, v60, v61
    v_max3_u32 v153, v153, v62, v63
    v_max_u32 v153, v153, v154
    v_cmp_eq_u32 vcc, -1, v153
    s_nop 0
    s_cbranch_vccz L_OB_OK
    s_cmp_gt_u32 s80, 0x8000
    s_cbranch_scc1 L_OB_OK
    s_sleep 8
    s_branch L_OB
L_OB_OK:
    v_mfma_f32_32x32x16_bf16 v[0:15], v[48:51], v[188:191], 0
    v_mfma_f32_32x32x16_bf16 v[0:15], v[52:55], v[192:195], v[0:15]
    s_nop 11
    v_add_f32 v8, 0x358637bd, v8
    v_rcp_f32 v8, v8
    s_nop 0
    v_pk_mul_f32 v[0:1], v[0:1], v[8:9] op_sel_hi:[1,0]
    v_pk_mul_f32 v[2:3], v[2:3], v[8:9] op_sel_hi:[1,0]
    v_pk_mul_f32 v[4:5], v[4:5], v[8:9] op_sel_hi:[1,0]
    v_pk_mul_f32 v[6:7], v[6:7], v[8:9] op_sel_hi:[1,0]
    v_cvt_pk_bf16_f32 v160, v0, v1
    v_cvt_pk_bf16_f32 v161, v2, v3
    v_cvt_pk_bf16_f32 v162, v4, v5
    v_cvt_pk_bf16_f32 v163, v6, v7
    buffer_store_dwordx4 v[160:163], v157, s[40:43], s89 offen offset:0 sc1
    v_mfma_f32_32x32x16_bf16 v[0:15], v[56:59], v[196:199], 0
    v_mfma_f32_32x32x16_bf16 v[0:15], v[60:63], v[200:203], v[0:15]
    s_nop 11
    v_add_f32 v8, 0x358637bd, v8
    v_rcp_f32 v8, v8
    s_nop 0
    v_pk_mul_f32 v[0:1], v[0:1], v[8:9] op_sel_hi:[1,0]
    v_pk_mul_f32 v[2:3], v[2:3], v[8:9] op_sel_hi:[1,0]
    v_pk_mul_f32 v[4:5], v[4:5], v[8:9] op_sel_hi:[1,0]
    v_pk_mul_f32 v[6:7], v[6:7], v[8:9] op_sel_hi:[1,0]
    v_cvt_pk_bf16_f32 v164, v0, v1
    v_cvt_pk_bf16_f32 v165, v2, v3
    v_cvt_pk_bf16_f32 v166, v4, v5
    v_cvt_pk_bf16_f32 v167, v6, v7
    buffer_store_dwordx4 v[164:167], v157, s[40:43], s89 offen offset:2048 sc1
    s_mov_b32 s68, 2
    s_nop 0
L_OB_DONE:
    buffer_load_dwordx2 v[100:101], v252, s[44:47], 0 offen offset:0
    buffer_load_dwordx2 v[102:103], v252, s[44:47], 0 offen offset:32
    buffer_load_dwordx2 v[104:105], v252, s[44:47], 0 offen offset:64
    buffer_load_dword v155, v249, s[40:43], 0 offen sc1
    s_waitcnt vmcnt(4)
    v_mov_b32 v158, 0
    s_mov_b64 exec, 4
    buffer_store_dword v158, v248, s[40:43], 0 offen sc1
    s_mov_b64 exec, -1
    s_barrier
    s_cmp_lg_u32 s83, -1
    s_cbranch_scc1 L_JOIN
    s_waitcnt vmcnt(1)
    v_mov_b32 v158, v155
    s_waitcnt vmcnt(1)
    v_cmp_ne_u32 vcc, 0, v158
    s_cbranch_vccz L_FX_OK
    s_mov_b32 s80, 0
L_FX:
    buffer_load_dword v158, v249, s[40:43], 0 offen sc1
    s_add_u32 s80, s80, 1
    s_cmp_gt_u32 s80, 0x20000
    s_cbranch_scc1 L_FX_OK
    s_waitcnt vmcnt(0)
    v_cmp_ne_u32 vcc, 0, v158
    s_cbranch_vccz L_FX_OK
    s_sleep 6
    s_branch L_FX
L_FX_OK:
    buffer_load_dwordx4 v[172:175], v157, s[40:43], s76 offen sc1
    buffer_load_dwordx2 v[176:177], v157, s[40:43], s77 offen sc1
    s_add_u32 s76, s76, 6144
    s_add_u32 s77, s77, 6144
    buffer_load_dwordx4 v[178:181], v157, s[40:43], s76 offen sc1
    buffer_load_dwordx2 v[182:183], v157, s[40:43], s77 offen sc1
    s_add_u32 s76, s76, 6144
    s_add_u32 s77, s77, 6144
    buffer_load_dwordx4 v[184:187], v157, s[40:43], s76 offen sc1
    buffer_load_dwordx2 v[188:189], v157, s[40:43], s77 offen sc1
    s_add_u32 s76, s76, 6144
    s_add_u32 s77, s77, 6144
    buffer_load_dwordx4 v[190:193], v157, s[40:43], s76 offen sc1
    buffer_load_dwordx2 v[194:195], v157, s[40:43], s77 offen sc1
    s_mov_b32 s69, 3184710632
    v_mov_b32 v99, 3222493025
    v_lshlrev_b32 v160, 16, v100
    v_and_b32 v161, 0xffff0000, v100
    v_lshlrev_b32 v162, 16, v101
    v_and_b32 v163, 0xffff0000, v101
    v_lshlrev_b32 v164, 16, v102
    v_and_b32 v165, 0xffff0000, v102
    v_lshlrev_b32 v166, 16, v103
    v_and_b32 v167, 0xffff0000, v103
    v_lshlrev_b32 v168, 16, v104
    v_and_b32 v169, 0xffff0000, v104
    v_lshlrev_b32 v170, 16, v105
    v_and_b32 v171, 0xffff0000, v105
    s_waitcnt vmcnt(6)
    v_lshlrev_b32 v0, 16, v172
    v_and_b32 v1, 0xffff0000, v172
    v_lshlrev_b32 v2, 16, v173
    v_and_b32 v3, 0xffff0000, v173
    v_lshlrev_b32 v16, 16, v174
    v_and_b32 v17, 0xffff0000, v174
    v_lshlrev_b32 v18, 16, v175
    v_and_b32 v19, 0xffff0000, v175
    v_lshlrev_b32 v32, 16, v176
    v_and_b32 v33, 0xffff0000, v176
    v_lshlrev_b32 v34, 16, v177
    v_and_b32 v35, 0xffff0000, v177
    s_waitcnt vmcnt(4)
    v_lshlrev_b32 v4, 16, v178
    v_and_b32 v5, 0xffff0000, v178
    v_lshlrev_b32 v6, 16, v179
    v_and_b32 v7, 0xffff0000, v179
    v_lshlrev_b32 v20, 16, v180
    v_and_b32 v21, 0xffff0000, v180
    v_lshlrev_b32 v22, 16, v181
    v_and_b32 v23, 0xffff0000, v181
    v_lshlrev_b32 v36, 16, v182
    v_and_b32 v37, 0xffff0000, v182
    v_lshlrev_b32 v38, 16, v183
    v_and_b32 v39, 0xffff0000, v183
    s_waitcnt vmcnt(2)
    v_lshlrev_b32 v8, 16, v184
    v_and_b32 v9, 0xffff0000, v184
    v_lshlrev_b32 v10, 16, v185
    v_and_b32 v11, 0xffff0000, v185
    v_lshlrev_b32 v24, 16, v186
    v_and_b32 v25, 0xffff0000, v186
    v_lshlrev_b32 v26, 16, v187
    v_and_b32 v27, 0xffff0000, v187
    v_lshlrev_b32 v40, 16, v188
    v_and_b32 v41, 0xffff0000, v188
    v_lshlrev_b32 v42, 16, v189
    v_and_b32 v43, 0xffff0000, v189
    s_waitcnt vmcnt(0)
    v_lshlrev_b32 v12, 16, v190
    v_and_b32 v13, 0xffff0000, v190
    v_lshlrev_b32 v14, 16, v191
    v_and_b32 v15, 0xffff0000, v191
    v_lshlrev_b32 v28, 16, v192
    v_and_b32 v29, 0xffff0000, v192
    v_lshlrev_b32 v30, 16, v193
    v_and_b32 v31, 0xffff0000, v193
    v_lshlrev_b32 v44, 16, v194
    v_and_b32 v45, 0xffff0000, v194
    v_lshlrev_b32 v46, 16, v195
    v_and_b32 v47, 0xffff0000, v195
    v_pk_add_f32 v[0:1], v[0:1], v[4:5]
    v_pk_add_f32 v[8:9], v[8:9], v[12:13]
    v_pk_add_f32 v[2:3], v[2:3], v[6:7]
    v_pk_add_f32 v[10:11], v[10:11], v[14:15]
    v_pk_add_f32 v[16:17], v[16:17], v[20:21]
    v_pk_add_f32 v[24:25], v[24:25], v[28:29]
    v_pk_add_f32 v[18:19], v[18:19], v[22:23]
    v_pk_add_f32 v[26:27], v[26:27], v[30:31]
    v_pk_add_f32 v[32:33], v[32:33], v[36:37]
    v_pk_add_f32 v[40:41], v[40:41], v[44:45]
    v_pk_add_f32 v[34:35], v[34:35], v[38:39]
    v_pk_add_f32 v[42:43], v[42:43], v[46:47]
    v_pk_add_f32 v[0:1], v[0:1], v[8:9]
    v_pk_add_f32 v[2:3], v[2:3], v[10:11]
    v_pk_add_f32 v[16:17], v[16:17], v[24:25]
    v_pk_add_f32 v[18:19], v[18:19], v[26:27]
    v_pk_add_f32 v[32:33], v[32:33], v[40:41]
    v_pk_add_f32 v[34:35], v[34:35], v[42:43]
    v_cvt_pk_bf16_f32 v4, v0, v1
    v_cvt_pk_bf16_f32 v5, v2, v3
    v_cvt_pk_bf16_f32 v20, v16, v17
    v_cvt_pk_bf16_f32 v21, v18, v19
    v_cvt_pk_bf16_f32 v36, v32, v33
    v_cvt_pk_bf16_f32 v37, v34, v35
    v_lshlrev_b32 v0, 16, v4
    v_and_b32 v1, 0xffff0000, v4
    v_lshlrev_b32 v2, 16, v5
    v_and_b32 v3, 0xffff0000, v5
    v_lshlrev_b32 v16, 16, v20
    v_and_b32 v17, 0xffff0000, v20
    v_lshlrev_b32 v18, 16, v21
    v_and_b32 v19, 0xffff0000, v21
    v_lshlrev_b32 v32, 16, v36
    v_and_b32 v33, 0xffff0000, v36
    v_lshlrev_b32 v34, 16, v37
    v_and_b32 v35, 0xffff0000, v37
    v_pk_add_f32 v[0:1], v[0:1], v[160:161]
    v_pk_add_f32 v[2:3], v[2:3], v[162:163]
    v_pk_add_f32 v[16:17], v[16:17], v[164:165]
    v_pk_add_f32 v[18:19], v[18:19], v[166:167]
    v_pk_add_f32 v[32:33], v[32:33], v[168:169]
    v_pk_add_f32 v[34:35], v[34:35], v[170:171]
    v_cvt_pk_bf16_f32 v4, v0, v1
    v_cvt_pk_bf16_f32 v5, v2, v3
    v_cvt_pk_bf16_f32 v20, v16, v17
    v_cvt_pk_bf16_f32 v21, v18, v19
    v_cvt_pk_bf16_f32 v36, v32, v33
    v_cvt_pk_bf16_f32 v37, v34, v35
    v_lshlrev_b32 v0, 16, v4
    v_and_b32 v1, 0xffff0000, v4
    v_lshlrev_b32 v2, 16, v5
    v_and_b32 v3, 0xffff0000, v5
    v_lshlrev_b32 v16, 16, v20
    v_and_b32 v17, 0xffff0000, v20
    v_lshlrev_b32 v18, 16, v21
    v_and_b32 v19, 0xffff0000, v21
    v_lshlrev_b32 v32, 16, v36
    v_and_b32 v33, 0xffff0000, v36
    v_lshlrev_b32 v34, 16, v37
    v_and_b32 v35, 0xffff0000, v37
    v_pk_mul_f32 v[4:5], v[0:1], v[0:1]
    v_pk_mul_f32 v[6:7], v[2:3], v[2:3]
    v_pk_mul_f32 v[20:21], v[16:17], v[16:17]
    v_pk_mul_f32 v[22:23], v[18:19], v[18:19]
    v_pk_mul_f32 v[36:37], v[32:33], v[32:33]
    v_pk_mul_f32 v[38:39], v[34:35], v[34:35]
    v_fma_f32 v4, v4, s69, v99
    v_fma_f32 v5, v5, s69, v99
    v_fma_f32 v6, v6, s69, v99
    v_fma_f32 v7, v7, s69, v99
    v_fma_f32 v20, v20, s69, v99
    v_fma_f32 v21, v21, s69, v99
    v_fma_f32 v22, v22, s69, v99
    v_fma_f32 v23, v23, s69, v99
    v_fma_f32 v36, v36, s69, v99
    v_fma_f32 v37, v37, s69, v99
    v_fma_f32 v38, v38, s69, v99
    v_fma_f32 v39, v39, s69, v99
    v_pk_mul_f32 v[4:5], v[4:5], v[0:1]
    v_pk_mul_f32 v[6:7], v[6:7], v[2:3]
    v_pk_mul_f32 v[20:21], v[20:21], v[16:17]
    v_pk_mul_f32 v[22:23], v[22:23], v[18:19]
    v_pk_mul_f32 v[36:37], v[36:37], v[32:33]
    v_pk_mul_f32 v[38:39], v[38:39], v[34:35]
    v_exp_f32 v4, v4
    v_exp_f32 v5, v5
    v_exp_f32 v6, v6
    v_exp_f32 v7, v7
    v_exp_f32 v20, v20
    v_exp_f32 v21, v21
    v_exp_f32 v22, v22
    v_exp_f32 v23, v23
    v_exp_f32 v36, v36
    v_exp_f32 v37, v37
    v_exp_f32 v38, v38
    v_exp_f32 v39, v39
    v_add_f32 v4, 1.0, v4
    v_add_f32 v5, 1.0, v5
    v_add_f32 v6, 1.0, v6
    v_add_f32 v7, 1.0, v7
    v_add_f32 v20, 1.0, v20
    v_add_f32 v21, 1.0, v21
    v_add_f32 v22, 1.0, v22
    v_add_f32 v23, 1.0, v23
    v_add_f32 v36, 1.0, v36
    v_add_f32 v37, 1.0, v37
    v_add_f32 v38, 1.0, v38
    v_add_f32 v39, 1.0, v39
    v_rcp_f32 v4, v4
    v_rcp_f32 v5, v5
    v_rcp_f32 v6, v6
    v_rcp_f32 v7, v7
    v_rcp_f32 v20, v20
    v_rcp_f32 v21, v21
    v_rcp_f32 v22, v22
    v_rcp_f32 v23, v23
    v_rcp_f32 v36, v36
    v_rcp_f32 v37, v37
    v_rcp_f32 v38, v38
    v_rcp_f32 v39, v39
    v_pk_mul_f32 v[0:1], v[0:1], v[4:5]
    v_pk_mul_f32 v[2:3], v[2:3], v[6:7]
    v_pk_mul_f32 v[16:17], v[16:17], v[20:21]
    v_pk_mul_f32 v[18:19], v[18:19], v[22:23]
    v_pk_mul_f32 v[32:33], v[32:33], v[36:37]
    v_pk_mul_f32 v[34:35], v[34:35], v[38:39]
    v_cvt_pk_bf16_f32 v88, v0, v1
    v_cvt_pk_bf16_f32 v89, v2, v3
    v_cvt_pk_bf16_f32 v90, v16, v17
    v_cvt_pk_bf16_f32 v91, v18, v19
    v_cvt_pk_bf16_f32 v92, v32, v33
    v_cvt_pk_bf16_f32 v93, v34, v35
    v_mov_b32 v94, v92
    v_mov_b32 v95, v93
    v_permlane32_swap_b32 v88, v90
    v_permlane32_swap_b32 v89, v91
    v_permlane32_swap_b32 v92, v94
    v_permlane32_swap_b32 v93, v95
    buffer_store_dwordx4 v[88:91], v253, s[40:43], s67 offen sc1
    s_mov_b32 exec_hi, 0
    buffer_store_dwordx4 v[92:95], v253, s[40:43], s3 offen sc1
    s_mov_b32 exec_hi, -1
    s_nop 0
L_JOIN:
    buffer_load_dword v155, v251, s[40:43], 0 offen sc1
    s_waitcnt vmcnt(1)
    v_mov_b32 v158, 0
    s_mov_b64 exec, 2
    buffer_store_dword v158, v248, s[40:43], 0 offen sc1
    s_mov_b64 exec, -1
    s_barrier
    s_mov_b32 s44, s20
    s_mov_b32 s45, s21
    s_mov_b32 s46, 4096
    s_lshl_b32 s66, s61, 7
    s_mov_b32 s76, 32768
    s_waitcnt vmcnt(1)
    v_mov_b32 v158, v155
    s_waitcnt vmcnt(1)
    v_cmp_ne_u32 vcc, 0, v158
    s_cbranch_vccz L_F5_OK
    s_mov_b32 s80, 0
L_F5:
    buffer_load_dword v158, v251, s[40:43], 0 offen sc1
    s_add_u32 s80, s80, 1
    s_cmp_gt_u32 s80, 0x20000
    s_cbranch_scc1 L_F5_OK
    s_waitcnt vmcnt(0)
    v_cmp_ne_u32 vcc, 0, v158
    s_cbranch_vccz L_F5_OK
    s_sleep 6
    s_branch L_F5
L_F5_OK:
    s_mov_b32 s87, 0
    buffer_load_dwordx4 v[160:163], v245, s[40:43], s87 offen offset:0 sc1
    buffer_load_dwordx4 v[164:167], v245, s[40:43], s87 offen offset:1024 sc1
    s_mov_b32 s87, 0
    buffer_load_dwordx4 v[168:171], v245, s[40:43], s87 offen offset:2048 sc1
    buffer_load_dwordx4 v[172:175], v245, s[40:43], s87 offen offset:3072 sc1
    s_mov_b32 s87, 4096
    buffer_load_dwordx4 v[176:179], v245, s[40:43], s87 offen offset:0 sc1
    buffer_load_dwordx4 v[180:183], v245, s[40:43], s87 offen offset:1024 sc1
    s_mov_b32 s87, 4096
    buffer_load_dwordx4 v[184:187], v245, s[40:43], s87 offen offset:2048 sc1
    buffer_load_dwordx4 v[188:191], v245, s[40:43], s87 offen offset:3072 sc1
    s_mov_b32 s87, 8192
    buffer_load_dwordx4 v[192:195], v245, s[40:43], s87 offen offset:0 sc1
    buffer_load_dwordx4 v[196:199], v245, s[40:43], s87 offen offset:1024 sc1
    s_mov_b32 s87, 8192
    buffer_load_dwordx4 v[200:203], v245, s[40:43], s87 offen offset:2048 sc1
    buffer_load_dwordx4 v[204:207], v245, s[40:43], s87 offen offset:3072 sc1
    ds_read_b64_tr_b16 v[84:85], v236 offset:0
    ds_read_b64_tr_b16 v[86:87], v236 offset:1024
    ds_read_b64_tr_b16 v[88:89], v237 offset:0
    ds_read_b64_tr_b16 v[90:91], v237 offset:1024
    s_waitcnt vmcnt(10)
    s_waitcnt lgkmcnt(0)
    v_mfma_f32_32x32x16_bf16 v[0:15], v[84:87], v[160:163], 0
    ds_read_b64_tr_b16 v[92:93], v236 offset:8192
    ds_read_b64_tr_b16 v[94:95], v236 offset:9216
    v_mfma_f32_32x32x16_bf16 v[16:31], v[84:87], v[164:167], 0
    ds_read_b64_tr_b16 v[96:97], v237 offset:8192
    ds_read_b64_tr_b16 v[98:99], v237 offset:9216
    s_mov_b32 s87, 12288
    buffer_load_dwordx4 v[208:211], v245, s[40:43], s87 offen offset:0 sc1
    buffer_load_dwordx4 v[212:215], v245, s[40:43], s87 offen offset:1024 sc1
    v_mfma_f32_32x32x16_bf16 v[32:47], v[88:91], v[160:163], 0
    s_mov_b32 s86, 786432
    s_add_u32 m0, s81, 0
    s_nop 0
    buffer_load_dwordx4 v234, s[56:59], s86 offen lds
    buffer_load_dwordx4 v235, s[56:59], s86 offen offset:1024 lds
    v_mfma_f32_32x32x16_bf16 v[48:63], v[88:91], v[164:167], 0
    s_waitcnt vmcnt(12)
    s_waitcnt lgkmcnt(0)
    v_mfma_f32_32x32x16_bf16 v[0:15], v[92:95], v[168:171], v[0:15]
    ds_read_b64_tr_b16 v[84:85], v236 offset:16384
    ds_read_b64_tr_b16 v[86:87], v236 offset:17408
    v_mfma_f32_32x32x16_bf16 v[16:31], v[92:95], v[172:175], v[16:31]
    ds_read_b64_tr_b16 v[88:89], v237 offset:16384
    ds_read_b64_tr_b16 v[90:91], v237 offset:17408
    s_mov_b32 s87, 12288
    buffer_load_dwordx4 v[160:163], v245, s[40:43], s87 offen offset:2048 sc1
    buffer_load_dwordx4 v[164:167], v245, s[40:43], s87 offen offset:3072 sc1
    v_mfma_f32_32x32x16_bf16 v[32:47], v[96:99], v[168:171], v[32:47]
    s_mov_b32 s86, 851968
    s_add_u32 m0, s81, 8192
    s_nop 0
    buffer_load_dwordx4 v234, s[56:59], s86 offen lds
    buffer_load_dwordx4 v235, s[56:59], s86 offen offset:1024 lds
    v_mfma_f32_32x32x16_bf16 v[48:63], v[96:99], v[172:175], v[48:63]
    s_waitcnt vmcnt(14)
    s_waitcnt lgkmcnt(0)
    v_mfma_f32_32x32x16_bf16 v[0:15], v[84:87], v[176:179], v[0:15]
    ds_read_b64_tr_b16 v[92:93], v236 offset:24576
    ds_read_b64_tr_b16 v[94:95], v236 offset:25600
    v_mfma_f32_32x32x16_bf16 v[16:31], v[84:87], v[180:183], v[16:31]
    ds_read_b64_tr_b16 v[96:97], v237 offset:24576
    ds_read_b64_tr_b16 v[98:99], v237 offset:25600
    v_mfma_f32_32x32x16_bf16 v[32:47], v[88:91], v[176:179], v[32:47]
    s_mov_b32 s86, 917504
    s_add_u32 m0, s81, 16384
    s_nop 0
    buffer_load_dwordx4 v234, s[56:59], s86 offen lds
    buffer_load_dwordx4 v235, s[56:59], s86 offen offset:1024 lds
    v_mfma_f32_32x32x16_bf16 v[48:63], v[88:91], v[180:183], v[48:63]
    s_waitcnt vmcnt(14)
    s_waitcnt lgkmcnt(0)
    v_mfma_f32_32x32x16_bf16 v[0:15], v[92:95], v[184:187], v[0:15]
    ds_read_b64_tr_b16 v[84:85], v236 offset:32768
    ds_read_b64_tr_b16 v[86:87], v236 offset:33792
    v_mfma_f32_32x32x16_bf16 v[16:31], v[92:95], v[188:191], v[16:31]
    ds_read_b64_tr_b16 v[88:89], v237 offset:32768
    ds_read_b64_tr_b16 v[90:91], v237 offset:33792
    v_mfma_f32_32x32x16_bf16 v[32:47], v[96:99], v[184:187], v[32:47]
    s_mov_b32 s86, 983040
    s_add_u32 m0, s81, 24576
    s_nop 0
    buffer_load_dwordx4 v234, s[56:59], s86 offen lds
    buffer_load_dwordx4 v235, s[56:59], s86 offen offset:1024 lds
    v_mfma_f32_32x32x16_bf16 v[48:63], v[96:99], v[188:191], v[48:63]
    buffer_load_dword v158, v250, s[40:43], 0 offen sc1
    s_waitcnt vmcnt(15)
    s_waitcnt lgkmcnt(0)
    v_mfma_f32_32x32x16_bf16 v[0:15], v[84:87], v[192:195], v[0:15]
    ds_read_b64_tr_b16 v[92:93], v236 offset:40960
    ds_read_b64_tr_b16 v[94:95], v236 offset:41984
    v_mfma_f32_32x32x16_bf16 v[16:31], v[84:87], v[196:199], v[16:31]
    ds_read_b64_tr_b16 v[96:97], v237 offset:40960
    ds_read_b64_tr_b16 v[98:99], v237 offset:41984
    v_mfma_f32_32x32x16_bf16 v[32:47], v[88:91], v[192:195], v[32:47]
    s_mov_b32 s86, 1048576
    s_add_u32 m0, s81, 32768
    s_nop 0
    buffer_load_dwordx4 v234, s[56:59], s86 offen lds
    buffer_load_dwordx4 v235, s[56:59], s86 offen offset:1024 lds
    v_mfma_f32_32x32x16_bf16 v[48:63], v[88:91], v[196:199], v[48:63]
    s_waitcnt vmcnt(15)
    s_waitcnt lgkmcnt(0)
    v_mfma_f32_32x32x16_bf16 v[0:15], v[92:95], v[200:203], v[0:15]
    ds_read_b64_tr_b16 v[84:85], v236 offset:49152
    ds_read_b64_tr_b16 v[86:87], v236 offset:50176
    v_mfma_f32_32x32x16_bf16 v[16:31], v[92:95], v[204:207], v[16:31]
    ds_read_b64_tr_b16 v[88:89], v237 offset:49152
    ds_read_b64_tr_b16 v[90:91], v237 offset:50176
    v_mfma_f32_32x32x16_bf16 v[32:47], v[96:99], v[200:203], v[32:47]
    s_mov_b32 s86, 1114112
    s_add_u32 m0, s81, 40960
    s_nop 0
    buffer_load_dwordx4 v234, s[56:59], s86 offen lds
    buffer_load_dwordx4 v235, s[56:59], s86 offen offset:1024 lds
    v_mfma_f32_32x32x16_bf16 v[48:63], v[96:99], v[204:207], v[48:63]
    s_waitcnt vmcnt(15)
    s_waitcnt lgkmcnt(0)
    v_mfma_f32_32x32x16_bf16 v[0:15], v[84:87], v[208:211], v[0:15]
    ds_read_b64_tr_b16 v[92:93], v238 offset:0
    ds_read_b64_tr_b16 v[94:95], v238 offset:1024
    v_mfma_f32_32x32x16_bf16 v[16:31], v[84:87], v[212:215], v[16:31]
    ds_read_b64_tr_b16 v[96:97], v239 offset:0
    ds_read_b64_tr_b16 v[98:99], v239 offset:1024
    v_mfma_f32_32x32x16_bf16 v[32:47], v[88:91], v[208:211], v[32:47]
    s_mov_b32 s86, 1179648
    s_add_u32 m0, s81, 49152
    s_nop 0
    buffer_load_dwordx4 v234, s[56:59], s86 offen lds
    buffer_load_dwordx4 v235, s[56:59], s86 offen offset:1024 lds
    v_mfma_f32_32x32x16_bf16 v[48:63], v[88:91], v[212:215], v[48:63]
    s_waitcnt vmcnt(6)
    v_cmp_ne_u32 vcc, 0, v158
    s_nop 9
    s_cbranch_vccz L_F4_OK
    s_mov_b32 s80, 0
L_F4:
    buffer_load_dword v158, v250, s[40:43], 0 offen sc1
    s_add_u32 s80, s80, 1
    s_cmp_gt_u32 s80, 0x20000
    s_cbranch_scc1 L_F4_OK
    s_waitcnt vmcnt(0)
    v_cmp_ne_u32 vcc, 0, v158
    s_cbranch_vccz L_F4_OK
    s_sleep 6
    s_branch L_F4
L_F4_OK:
    s_mov_b32 s87, 0
    buffer_load_dwordx4 v[168:171], v246, s[40:43], s87 offen offset:0 sc1
    buffer_load_dwordx4 v[172:175], v246, s[40:43], s87 offen offset:1024 sc1
    s_mov_b32 s87, 0
    buffer_load_dwordx4 v[176:179], v246, s[40:43], s87 offen offset:2048 sc1
    buffer_load_dwordx4 v[180:183], v246, s[40:43], s87 offen offset:3072 sc1
    s_mov_b32 s87, 4096
    buffer_load_dwordx4 v[184:187], v246, s[40:43], s87 offen offset:0 sc1
    buffer_load_dwordx4 v[188:191], v246, s[40:43], s87 offen offset:1024 sc1
    s_mov_b32 s87, 4096
    buffer_load_dwordx4 v[192:195], v246, s[40:43], s87 offen offset:2048 sc1
    buffer_load_dwordx4 v[196:199], v246, s[40:43], s87 offen offset:3072 sc1
    s_mov_b32 s87, 8192
    buffer_load_dwordx4 v[200:203], v246, s[40:43], s87 offen offset:0 sc1
    buffer_load_dwordx4 v[204:207], v246, s[40:43], s87 offen offset:1024 sc1
    s_waitcnt vmcnt(23)
    s_waitcnt lgkmcnt(0)
    v_mfma_f32_32x32x16_bf16 v[0:15], v[92:95], v[160:163], v[0:15]
    ds_read_b64_tr_b16 v[84:85], v238 offset:8192
    ds_read_b64_tr_b16 v[86:87], v238 offset:9216
    v_mfma_f32_32x32x16_bf16 v[16:31], v[92:95], v[164:167], v[16:31]
    ds_read_b64_tr_b16 v[88:89], v239 offset:8192
    ds_read_b64_tr_b16 v[90:91], v239 offset:9216
    s_mov_b32 s87, 8192
    buffer_load_dwordx4 v[208:211], v246, s[40:43], s87 offen offset:2048 sc1
    buffer_load_dwordx4 v[212:215], v246, s[40:43], s87 offen offset:3072 sc1
    v_mfma_f32_32x32x16_bf16 v[32:47], v[96:99], v[160:163], v[32:47]
    s_mov_b32 s86, 1245184
    s_add_u32 m0, s81, 57344
    s_nop 0
    buffer_load_dwordx4 v234, s[56:59], s86 offen lds
    buffer_load_dwordx4 v235, s[56:59], s86 offen offset:1024 lds
    v_mfma_f32_32x32x16_bf16 v[48:63], v[96:99], v[164:167], v[48:63]
    s_waitcnt vmcnt(12)
    s_waitcnt lgkmcnt(0)
    v_mfma_f32_32x32x16_bf16 v[0:15], v[168:171], v[84:87], v[0:15]
    ds_read_b64_tr_b16 v[92:93], v238 offset:16384
    ds_read_b64_tr_b16 v[94:95], v238 offset:17408
    v_mfma_f32_32x32x16_bf16 v[32:47], v[172:175], v[84:87], v[32:47]
    ds_read_b64_tr_b16 v[96:97], v239 offset:16384
    ds_read_b64_tr_b16 v[98:99], v239 offset:17408
    s_mov_b32 s87, 12288
    buffer_load_dwordx4 v[160:163], v246, s[40:43], s87 offen offset:0 sc1
    buffer_load_dwordx4 v[164:167], v246, s[40:43], s87 offen offset:1024 sc1
    v_mfma_f32_32x32x16_bf16 v[16:31], v[168:171], v[88:91], v[16:31]
    s_mov_b32 s86, 1310720
    s_add_u32 m0, s81, 65536
    s_nop 0
    buffer_load_dwordx4 v234, s[56:59], s86 offen lds
    buffer_load_dwordx4 v235, s[56:59], s86 offen offset:1024 lds
    v_mfma_f32_32x32x16_bf16 v[48:63], v[172:175], v[88:91], v[48:63]
    s_waitcnt vmcnt(14)
    s_waitcnt lgkmcnt(0)
    v_mfma_f32_32x32x16_bf16 v[0:15], v[176:179], v[92:95], v[0:15]
    ds_read_b64_tr_b16 v[84:85], v238 offset:24576
    ds_read_b64_tr_b16 v[86:87], v238 offset:25600
    v_mfma_f32_32x32x16_bf16 v[32:47], v[180:183], v[92:95], v[32:47]
    ds_read_b64_tr_b16 v[88:89], v239 offset:24576
    ds_read_b64_tr_b16 v[90:91], v239 offset:25600
    s_mov_b32 s87, 12288
    buffer_load_dwordx4 v[168:171], v246, s[40:43], s87 offen offset:2048 sc1
    buffer_load_dwordx4 v[172:175], v246, s[40:43], s87 offen offset:3072 sc1
    v_mfma_f32_32x32x16_bf16 v[16:31], v[176:179], v[96:99], v[16:31]
    s_mov_b32 s86, 1376256
    s_add_u32 m0, s81, 73728
    s_nop 0
    buffer_load_dwordx4 v234, s[56:59], s86 offen lds
    buffer_load_dwordx4 v235, s[56:59], s86 offen offset:1024 lds
    v_mfma_f32_32x32x16_bf16 v[48:63], v[180:183], v[96:99], v[48:63]
    s_waitcnt vmcnt(16)
    s_waitcnt lgkmcnt(0)
    v_mfma_f32_32x32x16_bf16 v[0:15], v[184:187], v[84:87], v[0:15]
    ds_read_b64_tr_b16 v[92:93], v238 offset:32768
    ds_read_b64_tr_b16 v[94:95], v238 offset:33792
    v_mfma_f32_32x32x16_bf16 v[32:47], v[188:191], v[84:87], v[32:47]
    ds_read_b64_tr_b16 v[96:97], v239 offset:32768
    ds_read_b64_tr_b16 v[98:99], v239 offset:33792
    s_mov_b32 s87, 16384
    buffer_load_dwordx4 v[176:179], v246, s[40:43], s87 offen offset:0 sc1
    buffer_load_dwordx4 v[180:183], v246, s[40:43], s87 offen offset:1024 sc1
    v_mfma_f32_32x32x16_bf16 v[16:31], v[184:187], v[88:91], v[16:31]
    v_mfma_f32_32x32x16_bf16 v[48:63], v[188:191], v[88:91], v[48:63]
    s_waitcnt vmcnt(16)
    s_waitcnt lgkmcnt(0)
    v_mfma_f32_32x32x16_bf16 v[0:15], v[192:195], v[92:95], v[0:15]
    ds_read_b64_tr_b16 v[84:85], v238 offset:40960
    ds_read_b64_tr_b16 v[86:87], v238 offset:41984
    v_mfma_f32_32x32x16_bf16 v[32:47], v[196:199], v[92:95], v[32:47]
    ds_read_b64_tr_b16 v[88:89], v239 offset:40960
    ds_read_b64_tr_b16 v[90:91], v239 offset:41984
    s_mov_b32 s87, 16384
    buffer_load_dwordx4 v[184:187], v246, s[40:43], s87 offen offset:2048 sc1
    buffer_load_dwordx4 v[188:191], v246, s[40:43], s87 offen offset:3072 sc1
    v_mfma_f32_32x32x16_bf16 v[16:31], v[192:195], v[96:99], v[16:31]
    v_mfma_f32_32x32x16_bf16 v[48:63], v[196:199], v[96:99], v[48:63]
    s_waitcnt vmcnt(16)
    s_waitcnt lgkmcnt(0)
    v_mfma_f32_32x32x16_bf16 v[0:15], v[200:203], v[84:87], v[0:15]
    ds_read_b64_tr_b16 v[92:93], v238 offset:49152
    ds_read_b64_tr_b16 v[94:95], v238 offset:50176
    v_mfma_f32_32x32x16_bf16 v[32:47], v[204:207], v[84:87], v[32:47]
    ds_read_b64_tr_b16 v[96:97], v239 offset:49152
    ds_read_b64_tr_b16 v[98:99], v239 offset:50176
    s_mov_b32 s87, 20480
    buffer_load_dwordx4 v[192:195], v246, s[40:43], s87 offen offset:0 sc1
    buffer_load_dwordx4 v[196:199], v246, s[40:43], s87 offen offset:1024 sc1
    v_mfma_f32_32x32x16_bf16 v[16:31], v[200:203], v[88:91], v[16:31]
    v_mfma_f32_32x32x16_bf16 v[48:63], v[204:207], v[88:91], v[48:63]
    buffer_load_dwordx4 v[104:107], v242, s[28:31], 0 offen
    buffer_load_dwordx4 v[108:111], v242, s[28:31], s76 offen
    buffer_load_ushort v112, v243, s[44:47], s66 offen
    buffer_load_ushort v113, v243, s[44:47], s66 offen offset:64
    s_waitcnt vmcnt(20)
    s_waitcnt lgkmcnt(0)
    v_mfma_f32_32x32x16_bf16 v[0:15], v[208:211], v[92:95], v[0:15]
    ds_read_b64_tr_b16 v[84:85], v240 offset:0
    ds_read_b64_tr_b16 v[86:87], v240 offset:1024
    v_mfma_f32_32x32x16_bf16 v[32:47], v[212:215], v[92:95], v[32:47]
    ds_read_b64_tr_b16 v[88:89], v241 offset:0
    ds_read_b64_tr_b16 v[90:91], v241 offset:1024
    s_mov_b32 s87, 20480
    buffer_load_dwordx4 v[200:203], v246, s[40:43], s87 offen offset:2048 sc1
    buffer_load_dwordx4 v[204:207], v246, s[40:43], s87 offen offset:3072 sc1
    v_mfma_f32_32x32x16_bf16 v[16:31], v[208:211], v[96:99], v[16:31]
    v_mfma_f32_32x32x16_bf16 v[48:63], v[212:215], v[96:99], v[48:63]
    s_waitcnt vmcnt(18)
    s_waitcnt lgkmcnt(0)
    v_mfma_f32_32x32x16_bf16 v[0:15], v[160:163], v[84:87], v[0:15]
    ds_read_b64_tr_b16 v[92:93], v240 offset:8192
    ds_read_b64_tr_b16 v[94:95], v240 offset:9216
    v_mfma_f32_32x32x16_bf16 v[32:47], v[164:167], v[84:87], v[32:47]
    ds_read_b64_tr_b16 v[96:97], v241 offset:8192
    ds_read_b64_tr_b16 v[98:99], v241 offset:9216
    s_mov_b32 s87, 24576
    buffer_load_dwordx4 v[208:211], v246, s[40:43], s87 offen offset:0 sc1
    buffer_load_dwordx4 v[212:215], v246, s[40:43], s87 offen offset:1024 sc1
    v_mfma_f32_32x32x16_bf16 v[16:31], v[160:163], v[88:91], v[16:31]
    v_mfma_f32_32x32x16_bf16 v[48:63], v[164:167], v[88:91], v[48:63]
    s_waitcnt vmcnt(16)
    s_waitcnt lgkmcnt(0)
    v_mfma_f32_32x32x16_bf16 v[0:15], v[168:171], v[92:95], v[0:15]
    ds_read_b64_tr_b16 v[84:85], v240 offset:16384
    ds_read_b64_tr_b16 v[86:87], v240 offset:17408
    v_mfma_f32_32x32x16_bf16 v[32:47], v[172:175], v[92:95], v[32:47]
    ds_read_b64_tr_b16 v[88:89], v241 offset:16384
    ds_read_b64_tr_b16 v[90:91], v241 offset:17408
    s_mov_b32 s87, 24576
    buffer_load_dwordx4 v[160:163], v246, s[40:43], s87 offen offset:2048 sc1
    buffer_load_dwordx4 v[164:167], v246, s[40:43], s87 offen offset:3072 sc1
    v_mfma_f32_32x32x16_bf16 v[16:31], v[168:171], v[96:99], v[16:31]
    v_mfma_f32_32x32x16_bf16 v[48:63], v[172:175], v[96:99], v[48:63]
    s_waitcnt vmcnt(14)
    s_waitcnt lgkmcnt(0)
    v_mfma_f32_32x32x16_bf16 v[0:15], v[176:179], v[84:87], v[0:15]
    ds_read_b64_tr_b16 v[92:93], v240 offset:24576
    ds_read_b64_tr_b16 v[94:95], v240 offset:25600
    v_mfma_f32_32x32x16_bf16 v[32:47], v[180:183], v[84:87], v[32:47]
    ds_read_b64_tr_b16 v[96:97], v241 offset:24576
    ds_read_b64_tr_b16 v[98:99], v241 offset:25600
    s_mov_b32 s87, 28672
    buffer_load_dwordx4 v[168:171], v246, s[40:43], s87 offen offset:0 sc1
    buffer_load_dwordx4 v[172:175], v246, s[40:43], s87 offen offset:1024 sc1
    v_mfma_f32_32x32x16_bf16 v[16:31], v[176:179], v[88:91], v[16:31]
    v_mfma_f32_32x32x16_bf16 v[48:63], v[180:183], v[88:91], v[48:63]
    s_waitcnt vmcnt(14)
    s_waitcnt lgkmcnt(0)
    v_mfma_f32_32x32x16_bf16 v[0:15], v[184:187], v[92:95], v[0:15]
    ds_read_b64_tr_b16 v[84:85], v240 offset:32768
    ds_read_b64_tr_b16 v[86:87], v240 offset:33792
    v_mfma_f32_32x32x16_bf16 v[32:47], v[188:191], v[92:95], v[32:47]
    ds_read_b64_tr_b16 v[88:89], v241 offset:32768
    ds_read_b64_tr_b16 v[90:91], v241 offset:33792
    s_mov_b32 s87, 28672
    buffer_load_dwordx4 v[176:179], v246, s[40:43], s87 offen offset:2048 sc1
    buffer_load_dwordx4 v[180:183], v246, s[40:43], s87 offen offset:3072 sc1
    v_mfma_f32_32x32x16_bf16 v[16:31], v[184:187], v[96:99], v[16:31]
    v_mfma_f32_32x32x16_bf16 v[48:63], v[188:191], v[96:99], v[48:63]
    s_waitcnt vmcnt(14)
    s_waitcnt lgkmcnt(0)
    v_mfma_f32_32x32x16_bf16 v[0:15], v[192:195], v[84:87], v[0:15]
    ds_read_b64_tr_b16 v[92:93], v240 offset:40960
    ds_read_b64_tr_b16 v[94:95], v240 offset:41984
    v_mfma_f32_32x32x16_bf16 v[32:47], v[196:199], v[84:87], v[32:47]
    ds_read_b64_tr_b16 v[96:97], v241 offset:40960
    ds_read_b64_tr_b16 v[98:99], v241 offset:41984
    s_mov_b32 s87, 32768
    buffer_load_dwordx4 v[184:187], v246, s[40:43], s87 offen offset:0 sc1
    buffer_load_dwordx4 v[188:191], v246, s[40:43], s87 offen offset:1024 sc1
    v_mfma_f32_32x32x16_bf16 v[16:31], v[192:195], v[88:91], v[16:31]
    v_mfma_f32_32x32x16_bf16 v[48:63], v[196:199], v[88:91], v[48:63]
    s_waitcnt vmcnt(10)
    s_waitcnt lgkmcnt(0)
    v_mfma_f32_32x32x16_bf16 v[0:15], v[200:203], v[92:95], v[0:15]
    ds_read_b64_tr_b16 v[84:85], v236 offset:0
    ds_read_b64_tr_b16 v[86:87], v236 offset:1024
    v_mfma_f32_32x32x16_bf16 v[32:47], v[204:207], v[92:95], v[32:47]
    ds_read_b64_tr_b16 v[88:89], v237 offset:0
    ds_read_b64_tr_b16 v[90:91], v237 offset:1024
    s_mov_b32 s87, 32768
    buffer_load_dwordx4 v[192:195], v246, s[40:43], s87 offen offset:2048 sc1
    buffer_load_dwordx4 v[196:199], v246, s[40:43], s87 offen offset:3072 sc1
    v_mfma_f32_32x32x16_bf16 v[16:31], v[200:203], v[96:99], v[16:31]
    v_mfma_f32_32x32x16_bf16 v[48:63], v[204:207], v[96:99], v[48:63]
    s_waitcnt vmcnt(10)
    s_waitcnt lgkmcnt(0)
    v_mfma_f32_32x32x16_bf16 v[0:15], v[208:211], v[84:87], v[0:15]
    ds_read_b64_tr_b16 v[92:93], v236 offset:8192
    ds_read_b64_tr_b16 v[94:95], v236 offset:9216
    v_mfma_f32_32x32x16_bf16 v[32:47], v[212:215], v[84:87], v[32:47]
    ds_read_b64_tr_b16 v[96:97], v237 offset:8192
    ds_read_b64_tr_b16 v[98:99], v237 offset:9216
    s_mov_b32 s87, 36864
    buffer_load_dwordx4 v[200:203], v246, s[40:43], s87 offen offset:0 sc1
    buffer_load_dwordx4 v[204:207], v246, s[40:43], s87 offen offset:1024 sc1
    v_mfma_f32_32x32x16_bf16 v[16:31], v[208:211], v[88:91], v[16:31]
    v_mfma_f32_32x32x16_bf16 v[48:63], v[212:215], v[88:91], v[48:63]
    s_waitcnt vmcnt(10)
    s_waitcnt lgkmcnt(0)
    v_mfma_f32_32x32x16_bf16 v[0:15], v[160:163], v[92:95], v[0:15]
    ds_read_b64_tr_b16 v[84:85], v236 offset:16384
    ds_read_b64_tr_b16 v[86:87], v236 offset:17408
    v_mfma_f32_32x32x16_bf16 v[32:47], v[164:167], v[92:95], v[32:47]
    ds_read_b64_tr_b16 v[88:89], v237 offset:16384
    ds_read_b64_tr_b16 v[90:91], v237 offset:17408
    s_mov_b32 s87, 36864
    buffer_load_dwordx4 v[208:211], v246, s[40:43], s87 offen offset:2048 sc1
    buffer_load_dwordx4 v[212:215], v246, s[40:43], s87 offen offset:3072 sc1
    v_mfma_f32_32x32x16_bf16 v[16:31], v[160:163], v[96:99], v[16:31]
    v_mfma_f32_32x32x16_bf16 v[48:63], v[164:167], v[96:99], v[48:63]
    s_waitcnt vmcnt(10)
    s_waitcnt lgkmcnt(0)
    v_mfma_f32_32x32x16_bf16 v[0:15], v[168:171], v[84:87], v[0:15]
    ds_read_b64_tr_b16 v[92:93], v236 offset:24576
    ds_read_b64_tr_b16 v[94:95], v236 offset:25600
    v_mfma_f32_32x32x16_bf16 v[32:47], v[172:175], v[84:87], v[32:47]
    ds_read_b64_tr_b16 v[96:97], v237 offset:24576
    ds_read_b64_tr_b16 v[98:99], v237 offset:25600
    s_mov_b32 s87, 40960
    buffer_load_dwordx4 v[160:163], v246, s[40:43], s87 offen offset:0 sc1
    buffer_load_dwordx4 v[164:167], v246, s[40:43], s87 offen offset:1024 sc1
    v_mfma_f32_32x32x16_bf16 v[16:31], v[168:171], v[88:91], v[16:31]
    v_mfma_f32_32x32x16_bf16 v[48:63], v[172:175], v[88:91], v[48:63]
    s_waitcnt vmcnt(10)
    s_waitcnt lgkmcnt(0)
    v_mfma_f32_32x32x16_bf16 v[0:15], v[176:179], v[92:95], v[0:15]
    ds_read_b64_tr_b16 v[84:85], v236 offset:32768
    ds_read_b64_tr_b16 v[86:87], v236 offset:33792
    v_mfma_f32_32x32x16_bf16 v[32:47], v[180:183], v[92:95], v[32:47]
    ds_read_b64_tr_b16 v[88:89], v237 offset:32768
    ds_read_b64_tr_b16 v[90:91], v237 offset:33792
    s_mov_b32 s87, 40960
    buffer_load_dwordx4 v[168:171], v246, s[40:43], s87 offen offset:2048 sc1
    buffer_load_dwordx4 v[172:175], v246, s[40:43], s87 offen offset:3072 sc1
    v_mfma_f32_32x32x16_bf16 v[16:31], v[176:179], v[96:99], v[16:31]
    v_mfma_f32_32x32x16_bf16 v[48:63], v[180:183], v[96:99], v[48:63]
    s_barrier
    s_waitcnt vmcnt(10)
    s_waitcnt lgkmcnt(0)
    v_mfma_f32_32x32x16_bf16 v[0:15], v[184:187], v[84:87], v[0:15]
    ds_read_b64_tr_b16 v[92:93], v236 offset:40960
    ds_read_b64_tr_b16 v[94:95], v236 offset:41984
    v_mfma_f32_32x32x16_bf16 v[32:47], v[188:191], v[84:87], v[32:47]
    ds_read_b64_tr_b16 v[96:97], v237 offset:40960
    ds_read_b64_tr_b16 v[98:99], v237 offset:41984
    v_mfma_f32_32x32x16_bf16 v[16:31], v[184:187], v[88:91], v[16:31]
    v_mfma_f32_32x32x16_bf16 v[48:63], v[188:191], v[88:91], v[48:63]
    s_waitcnt vmcnt(8)
    s_waitcnt lgkmcnt(0)
    v_mfma_f32_32x32x16_bf16 v[0:15], v[192:195], v[92:95], v[0:15]
    ds_read_b64_tr_b16 v[84:85], v236 offset:49152
    ds_read_b64_tr_b16 v[86:87], v236 offset:50176
    v_mfma_f32_32x32x16_bf16 v[32:47], v[196:199], v[92:95], v[32:47]
    ds_read_b64_tr_b16 v[88:89], v237 offset:49152
    ds_read_b64_tr_b16 v[90:91], v237 offset:50176
    v_mfma_f32_32x32x16_bf16 v[16:31], v[192:195], v[96:99], v[16:31]
    v_mfma_f32_32x32x16_bf16 v[48:63], v[196:199], v[96:99], v[48:63]
    s_waitcnt vmcnt(6)
    s_waitcnt lgkmcnt(0)
    v_mfma_f32_32x32x16_bf16 v[0:15], v[200:203], v[84:87], v[0:15]
    ds_read_b64_tr_b16 v[92:93], v238 offset:0
    ds_read_b64_tr_b16 v[94:95], v238 offset:1024
    v_mfma_f32_32x32x16_bf16 v[32:47], v[204:207], v[84:87], v[32:47]
    ds_read_b64_tr_b16 v[96:97], v239 offset:0
    ds_read_b64_tr_b16 v[98:99], v239 offset:1024
    v_mfma_f32_32x32x16_bf16 v[16:31], v[200:203], v[88:91], v[16:31]
    v_mfma_f32_32x32x16_bf16 v[48:63], v[204:207], v[88:91], v[48:63]
    s_waitcnt vmcnt(4)
    s_waitcnt lgkmcnt(0)
    v_mfma_f32_32x32x16_bf16 v[0:15], v[208:211], v[92:95], v[0:15]
    ds_read_b64_tr_b16 v[84:85], v238 offset:8192
    ds_read_b64_tr_b16 v[86:87], v238 offset:9216
    v_mfma_f32_32x32x16_bf16 v[32:47], v[212:215], v[92:95], v[32:47]
    ds_read_b64_tr_b16 v[88:89], v239 offset:8192
    ds_read_b64_tr_b16 v[90:91], v239 offset:9216
    v_mfma_f32_32x32x16_bf16 v[16:31], v[208:211], v[96:99], v[16:31]
    v_mfma_f32_32x32x16_bf16 v[48:63], v[212:215], v[96:99], v[48:63]
    s_waitcnt vmcnt(2)
    s_waitcnt lgkmcnt(0)
    v_mfma_f32_32x32x16_bf16 v[0:15], v[160:163], v[84:87], v[0:15]
    ds_read_b64_tr_b16 v[92:93], v238 offset:16384
    ds_read_b64_tr_b16 v[94:95], v238 offset:17408
    v_mfma_f32_32x32x16_bf16 v[32:47], v[164:167], v[84:87], v[32:47]
    ds_read_b64_tr_b16 v[96:97], v239 offset:16384
    ds_read_b64_tr_b16 v[98:99], v239 offset:17408
    v_mfma_f32_32x32x16_bf16 v[16:31], v[160:163], v[88:91], v[16:31]
    v_mfma_f32_32x32x16_bf16 v[48:63], v[164:167], v[88:91], v[48:63]
    s_waitcnt vmcnt(0)
    s_waitcnt lgkmcnt(0)
    v_mfma_f32_32x32x16_bf16 v[0:15], v[168:171], v[92:95], v[0:15]
    v_mfma_f32_32x32x16_bf16 v[32:47], v[172:175], v[92:95], v[32:47]
    v_mfma_f32_32x32x16_bf16 v[16:31], v[168:171], v[96:99], v[16:31]
    v_mfma_f32_32x32x16_bf16 v[48:63], v[172:175], v[96:99], v[48:63]
    s_mov_b32 s56, s22
    s_mov_b32 s57, s23
    s_mov_b32 s58, 2097152
    s_mov_b32 s59, 0x20000
    s_mul_i32 s64, s60, 17408
    v_mul_u32_u24 v64, 272, v145
    v_lshl_add_u32 v64, v146, 4, v64
    v_add_u32 v64, s64, v64
    v_add_u32 v64, 81920, v64
    ds_write_b128 v64, v[0:3] offset:0
    ds_write_b128 v64, v[4:7] offset:32
    ds_write_b128 v64, v[8:11] offset:64
    ds_write_b128 v64, v[12:15] offset:96
    ds_write_b128 v64, v[16:19] offset:8704
    ds_write_b128 v64, v[20:23] offset:8736
    ds_write_b128 v64, v[24:27] offset:8768
    ds_write_b128 v64, v[28:31] offset:8800
    ds_write_b128 v64, v[32:35] offset:128
    ds_write_b128 v64, v[36:39] offset:160
    ds_write_b128 v64, v[40:43] offset:192
    ds_write_b128 v64, v[44:47] offset:224
    ds_write_b128 v64, v[48:51] offset:8832
    ds_write_b128 v64, v[52:55] offset:8864
    ds_write_b128 v64, v[56:59] offset:8896
    ds_write_b128 v64, v[60:63] offset:8928
    v_lshlrev_b32 v112, 16, v112
    v_lshlrev_b32 v66, 16, v104
    v_and_b32 v67, 0xffff0000, v104
    v_lshlrev_b32 v68, 16, v105
    v_and_b32 v69, 0xffff0000, v105
    v_lshlrev_b32 v70, 16, v106
    v_and_b32 v71, 0xffff0000, v106
    v_lshlrev_b32 v72, 16, v107
    v_and_b32 v73, 0xffff0000, v107
    v_lshlrev_b32 v113, 16, v113
    v_lshlrev_b32 v74, 16, v108
    v_and_b32 v75, 0xffff0000, v108
    v_lshlrev_b32 v76, 16, v109
    v_and_b32 v77, 0xffff0000, v109
    v_lshlrev_b32 v78, 16, v110
    v_and_b32 v79, 0xffff0000, v110
    v_lshlrev_b32 v80, 16, v111
    v_and_b32 v81, 0xffff0000, v111
    v_pk_add_f32 v[66:67], v[66:67], v[112:113] op_sel_hi:[1,0]
    v_pk_add_f32 v[68:69], v[68:69], v[112:113] op_sel_hi:[1,0]
    v_pk_add_f32 v[70:71], v[70:71], v[112:113] op_sel_hi:[1,0]
    v_pk_add_f32 v[72:73], v[72:73], v[112:113] op_sel_hi:[1,0]
    v_pk_add_f32 v[74:75], v[74:75], v[112:113] op_sel:[0,1] op_sel_hi:[1,1]
    v_pk_add_f32 v[76:77], v[76:77], v[112:113] op_sel:[0,1] op_sel_hi:[1,1]
    v_pk_add_f32 v[78:79], v[78:79], v[112:113] op_sel:[0,1] op_sel_hi:[1,1]
    v_pk_add_f32 v[80:81], v[80:81], v[112:113] op_sel:[0,1] op_sel_hi:[1,1]
    s_waitcnt lgkmcnt(0)
    s_barrier
    ds_read_b128 v[0:3], v244 offset:0
    ds_read_b128 v[4:7], v244 offset:16
    ds_read_b128 v[8:11], v244 offset:17408
    ds_read_b128 v[12:15], v244 offset:17424
    ds_read_b128 v[16:19], v244 offset:34816
    ds_read_b128 v[20:23], v244 offset:34832
    ds_read_b128 v[24:27], v244 offset:52224
    ds_read_b128 v[28:31], v244 offset:52240
    ds_read_b128 v[32:35], v244 offset:8704
    ds_read_b128 v[36:39], v244 offset:8720
    ds_read_b128 v[40:43], v244 offset:26112
    ds_read_b128 v[44:47], v244 offset:26128
    ds_read_b128 v[48:51], v244 offset:43520
    ds_read_b128 v[52:55], v244 offset:43536
    ds_read_b128 v[56:59], v244 offset:60928
    ds_read_b128 v[60:63], v244 offset:60944
    s_waitcnt lgkmcnt(8)
    v_pk_add_f32 v[0:1], v[0:1], v[8:9]
    v_pk_add_f32 v[16:17], v[16:17], v[24:25]
    v_pk_add_f32 v[2:3], v[2:3], v[10:11]
    v_pk_add_f32 v[18:19], v[18:19], v[26:27]
    v_pk_add_f32 v[4:5], v[4:5], v[12:13]
    v_pk_add_f32 v[20:21], v[20:21], v[28:29]
    v_pk_add_f32 v[6:7], v[6:7], v[14:15]
    v_pk_add_f32 v[22:23], v[22:23], v[30:31]
    v_pk_add_f32 v[0:1], v[0:1], v[16:17]
    v_pk_add_f32 v[2:3], v[2:3], v[18:19]
    v_pk_add_f32 v[4:5], v[4:5], v[20:21]
    v_pk_add_f32 v[6:7], v[6:7], v[22:23]
    v_pk_add_f32 v[0:1], v[0:1], v[66:67]
    v_pk_add_f32 v[2:3], v[2:3], v[68:69]
    v_pk_add_f32 v[4:5], v[4:5], v[70:71]
    v_pk_add_f32 v[6:7], v[6:7], v[72:73]
    v_cvt_pk_bf16_f32 v16, v0, v1
    v_cvt_pk_bf16_f32 v17, v2, v3
    v_cvt_pk_bf16_f32 v18, v4, v5
    v_cvt_pk_bf16_f32 v19, v6, v7
    buffer_store_dwordx4 v[16:19], v242, s[56:59], 0 offen
    s_waitcnt lgkmcnt(0)
    v_pk_add_f32 v[32:33], v[32:33], v[40:41]
    v_pk_add_f32 v[48:49], v[48:49], v[56:57]
    v_pk_add_f32 v[34:35], v[34:35], v[42:43]
    v_pk_add_f32 v[50:51], v[50:51], v[58:59]
    v_pk_add_f32 v[36:37], v[36:37], v[44:45]
    v_pk_add_f32 v[52:53], v[52:53], v[60:61]
    v_pk_add_f32 v[38:39], v[38:39], v[46:47]
    v_pk_add_f32 v[54:55], v[54:55], v[62:63]
    v_pk_add_f32 v[32:33], v[32:33], v[48:49]
    v_pk_add_f32 v[34:35], v[34:35], v[50:51]
    v_pk_add_f32 v[36:37], v[36:37], v[52:53]
    v_pk_add_f32 v[38:39], v[38:39], v[54:55]
    v_pk_add_f32 v[32:33], v[32:33], v[74:75]
    v_pk_add_f32 v[34:35], v[34:35], v[76:77]
    v_pk_add_f32 v[36:37], v[36:37], v[78:79]
    v_pk_add_f32 v[38:39], v[38:39], v[80:81]
    v_cvt_pk_bf16_f32 v48, v32, v33
    v_cvt_pk_bf16_f32 v49, v34, v35
    v_cvt_pk_bf16_f32 v50, v36, v37
    v_cvt_pk_bf16_f32 v51, v38, v39
    buffer_store_dwordx4 v[48:51], v242, s[56:59], s76 offen
    s_nop 1
L_END:
    s_endpgm
L_LOAD:
    s_sub_u32 s63, s60, 4
    s_lshl_b32 s77, s63, 12
    s_mul_i32 s78, s63, 12288
    s_mul_i32 s81, s63, 6144
    s_lshl_b32 s82, s63, 13
    s_lshl_b32 s64, s61, 16
    s_lshl_b32 s65, s63, 15
    s_add_u32 s64, s64, s65
    v_xor_b32 v153, v152, v148
    v_lshlrev_b32 v153, 4, v153
    v_lshl_add_u32 v153, v151, 10, v153
    v_add_u32 v1, s64, v153
    v_xor_b32 v2, 64, v1
    v_add_u32 v2, 7168, v2
    s_lshl_b32 s65, s62, 7
    s_mul_i32 s66, s63, 98304
    s_add_u32 s65, s65, s66
    v_and_b32 v153, 1, v148
    v_lshlrev_b32 v153, 2, v153
    v_xor_b32 v153, v152, v153
    v_lshlrev_b32 v153, 4, v153
    v_mul_u32_u24 v154, 3072, v151
    v_add3_u32 v3, v153, v154, s65
    s_lshl_b32 s65, s61, 7
    s_mul_i32 s66, s63, 2883584
    s_add_u32 s65, s65, s66
    v_lshl_add_u32 v9, v151, 12, v153
    v_add_u32 v9, s65, v9
    v_add_u32 v10, 31744, v9
    s_waitcnt lgkmcnt(0)
    s_mov_b32 s28, s4
    s_mov_b32 s29, s5
    s_mov_b32 s30, 2097152
    s_mov_b32 s31, 0x20000
    s_mov_b32 s32, s6
    s_mov_b32 s33, s7
    s_mov_b32 s34, 1572864
    s_mov_b32 s35, 0x20000
    s_mov_b32 s69, 0
    s_add_u32 m0, s77, 0
    s_nop 0
    buffer_load_dwordx4 v1, s[28:31], s69 offen lds
    buffer_load_dwordx4 v2, s[28:31], s69 offen offset:1024 lds
    s_mov_b32 s69, 16384
    s_add_u32 m0, s77, 2048
    s_nop 0
    buffer_load_dwordx4 v1, s[28:31], s69 offen lds
    buffer_load_dwordx4 v2, s[28:31], s69 offen offset:1024 lds
    s_mov_b32 s69, 1024
    s_add_u32 m0, s82, 65536
    s_nop 0
    buffer_load_dwordx4 v3, s[32:35], s69 offen lds
    buffer_load_dwordx4 v3, s[32:35], s69 offen offset:1024 lds
    s_mov_b32 s69, 25600
    s_add_u32 m0, s82, 67584
    s_nop 0
    buffer_load_dwordx4 v3, s[32:35], s69 offen lds
    buffer_load_dwordx4 v3, s[32:35], s69 offen offset:1024 lds
    s_mov_b32 s69, 50176
    s_add_u32 m0, s82, 69632
    s_nop 0
    buffer_load_dwordx4 v3, s[32:35], s69 offen lds
    buffer_load_dwordx4 v3, s[32:35], s69 offen offset:1024 lds
    s_mov_b32 s69, 74752
    s_add_u32 m0, s82, 71680
    s_nop 0
    buffer_load_dwordx4 v3, s[32:35], s69 offen lds
    buffer_load_dwordx4 v3, s[32:35], s69 offen offset:1024 lds
    s_mov_b32 s48, s8
    s_mov_b32 s49, s9
    s_mov_b32 s50, 16384
    s_mov_b32 s51, 0x20000
    s_lshl_b32 s64, s62, 11
    s_mov_b32 m0, 161792
    s_nop 0
    buffer_load_dwordx4 v157, s[48:51], s64 offen lds
    buffer_load_dwordx4 v157, s[48:51], s64 offen offset:1024 lds
    s_mov_b32 s69, 128
    s_add_u32 m0, s77, 8192
    s_nop 0
    buffer_load_dwordx4 v1, s[28:31], s69 offen lds
    buffer_load_dwordx4 v2, s[28:31], s69 offen offset:1024 lds
    s_mov_b32 s69, 16512
    s_add_u32 m0, s77, 10240
    s_nop 0
    buffer_load_dwordx4 v1, s[28:31], s69 offen lds
    buffer_load_dwordx4 v2, s[28:31], s69 offen offset:1024 lds
    s_mov_b32 s69, 197632
    s_add_u32 m0, s82, 81920
    s_nop 0
    buffer_load_dwordx4 v3, s[32:35], s69 offen lds
    buffer_load_dwordx4 v3, s[32:35], s69 offen offset:1024 lds
    s_mov_b32 s69, 222208
    s_add_u32 m0, s82, 83968
    s_nop 0
    buffer_load_dwordx4 v3, s[32:35], s69 offen lds
    buffer_load_dwordx4 v3, s[32:35], s69 offen offset:1024 lds
    s_mov_b32 s69, 246784
    s_add_u32 m0, s82, 86016
    s_nop 0
    buffer_load_dwordx4 v3, s[32:35], s69 offen lds
    buffer_load_dwordx4 v3, s[32:35], s69 offen offset:1024 lds
    s_mov_b32 s69, 271360
    s_add_u32 m0, s82, 88064
    s_nop 0
    buffer_load_dwordx4 v3, s[32:35], s69 offen lds
    buffer_load_dwordx4 v3, s[32:35], s69 offen offset:1024 lds
    s_lshr_b32 s12, s72, 1
    s_and_b32 s64, s72, 1
    s_mul_i32 s13, s64, 30
    s_add_u32 s13, s13, s73
    s_lshr_b32 s75, s13, 2
    s_and_b32 s74, s13, 3
    s_mul_i32 s64, s75, 192
    s_add_u32 s36, s14, s64
    s_addc_u32 s37, s15, 0
    s_mov_b32 s38, 0
    s_mov_b32 s39, 0x20000
    s_sub_u32 s38, 5636096, s64
    s_mov_b32 s44, s26
    s_mov_b32 s45, s27
    s_mov_b32 s46, 2097152
    s_mov_b32 s47, 0x20000
    s_cmp_ge_u32 s73, 30
    s_cselect_b32 s46, 0, s46
    s_cselect_b32 s38, 0, s38
    s_mov_b32 s52, s24
    s_mov_b32 s53, s25
    s_mov_b32 s54, 256
    s_mov_b32 s55, 0x20000
    s_mov_b32 s56, s18
    s_mov_b32 s57, s19
    s_mov_b32 s58, 5636096
    s_mov_b32 s59, 0x20000
    s_mul_i32 s76, s12, 1409024
    s_mul_i32 s64, s63, 88064
    s_add_u32 s76, s76, s64
    s_lshl_b32 s64, s74, 19
    s_lshl_b32 s65, s12, 14
    s_add_u32 s64, s64, s65
    s_lshl_b32 s65, s63, 18
    s_add_u32 s64, s64, s65
    v_add_u32 v7, s64, v157
    v_add_u32 v8, 63488, v7
    v_add_u32 v153, 0, v144
    v_mul_u32_u24 v154, 5462, v153
    v_lshrrev_b32 v154, 16, v154
    v_mul_u32_u24 v155, 12, v154
    v_sub_u32 v153, v153, v155
    v_bfe_u32 v155, v154, 3, 1
    v_lshlrev_b32 v155, 1, v155
    v_xor_b32 v153, v153, v155
    v_mul_u32_u24 v154, 2752, v154
    v_lshl_add_u32 v4, v153, 4, v154
    v_add_u32 v4, s76, v4
    v_add_u32 v153, 64, v144
    v_mul_u32_u24 v154, 5462, v153
    v_lshrrev_b32 v154, 16, v154
    v_mul_u32_u24 v155, 12, v154
    v_sub_u32 v153, v153, v155
    v_bfe_u32 v155, v154, 3, 1
    v_lshlrev_b32 v155, 1, v155
    v_xor_b32 v153, v153, v155
    v_mul_u32_u24 v154, 2752, v154
    v_lshl_add_u32 v5, v153, 4, v154
    v_add_u32 v5, s76, v5
    v_subrev_u32 v5, 1024, v5
    v_add_u32 v153, 128, v144
    v_mul_u32_u24 v154, 5462, v153
    v_lshrrev_b32 v154, 16, v154
    v_mul_u32_u24 v155, 12, v154
    v_sub_u32 v153, v153, v155
    v_bfe_u32 v155, v154, 3, 1
    v_lshlrev_b32 v155, 1, v155
    v_xor_b32 v153, v153, v155
    v_mul_u32_u24 v154, 2752, v154
    v_lshl_add_u32 v6, v153, 4, v154
    v_add_u32 v6, s76, v6
    v_subrev_u32 v6, 2048, v6
    v_and_b32 v153, 1, v144
    s_lshl_b32 s66, s12, 1
    v_add_lshl_u32 v159, v153, s66, 5
    s_mov_b32 s48, s10
    s_mov_b32 s49, s11
    s_mov_b32 s50, 524288
    s_mov_b32 s51, 0x20000
    v_and_b32 v153, 1, v148
    v_lshlrev_b32 v153, 2, v153
    v_xor_b32 v153, v152, v153
    v_lshlrev_b32 v153, 4, v153
    s_lshl_b32 s65, s62, 7
    s_lshl_b32 s66, s63, 18
    s_add_u32 s65, s65, s66
    v_lshl_add_u32 v11, v151, 10, v153
    v_add_u32 v11, s65, v11
    v_add_u32 v12, 7168, v11
    s_waitcnt vmcnt(12)
    s_barrier
    s_mov_b32 s69, 256
    s_add_u32 m0, s77, 16384
    s_nop 0
    buffer_load_dwordx4 v1, s[28:31], s69 offen lds
    buffer_load_dwordx4 v2, s[28:31], s69 offen offset:1024 lds
    s_mov_b32 s69, 16640
    s_add_u32 m0, s77, 18432
    s_nop 0
    buffer_load_dwordx4 v1, s[28:31], s69 offen lds
    buffer_load_dwordx4 v2, s[28:31], s69 offen offset:1024 lds
    s_mov_b32 s69, 394240
    s_add_u32 m0, s82, 98304
    s_nop 0
    buffer_load_dwordx4 v3, s[32:35], s69 offen lds
    buffer_load_dwordx4 v3, s[32:35], s69 offen offset:1024 lds
    s_mov_b32 s69, 418816
    s_add_u32 m0, s82, 100352
    s_nop 0
    buffer_load_dwordx4 v3, s[32:35], s69 offen lds
    buffer_load_dwordx4 v3, s[32:35], s69 offen offset:1024 lds
    s_mov_b32 s69, 443392
    s_add_u32 m0, s82, 102400
    s_nop 0
    buffer_load_dwordx4 v3, s[32:35], s69 offen lds
    buffer_load_dwordx4 v3, s[32:35], s69 offen offset:1024 lds
    s_mov_b32 s69, 467968
    s_add_u32 m0, s82, 104448
    s_nop 0
    buffer_load_dwordx4 v3, s[32:35], s69 offen lds
    buffer_load_dwordx4 v3, s[32:35], s69 offen offset:1024 lds
    s_mov_b32 s69, 384
    s_add_u32 m0, s77, 24576
    s_nop 0
    buffer_load_dwordx4 v1, s[28:31], s69 offen lds
    buffer_load_dwordx4 v2, s[28:31], s69 offen offset:1024 lds
    s_mov_b32 s69, 16768
    s_add_u32 m0, s77, 26624
    s_nop 0
    buffer_load_dwordx4 v1, s[28:31], s69 offen lds
    buffer_load_dwordx4 v2, s[28:31], s69 offen offset:1024 lds
    s_mov_b32 s69, 590848
    s_add_u32 m0, s82, 114688
    s_nop 0
    buffer_load_dwordx4 v3, s[32:35], s69 offen lds
    buffer_load_dwordx4 v3, s[32:35], s69 offen offset:1024 lds
    s_mov_b32 s69, 615424
    s_add_u32 m0, s82, 116736
    s_nop 0
    buffer_load_dwordx4 v3, s[32:35], s69 offen lds
    buffer_load_dwordx4 v3, s[32:35], s69 offen offset:1024 lds
    s_mov_b32 s69, 640000
    s_add_u32 m0, s82, 118784
    s_nop 0
    buffer_load_dwordx4 v3, s[32:35], s69 offen lds
    buffer_load_dwordx4 v3, s[32:35], s69 offen offset:1024 lds
    s_mov_b32 s69, 664576
    s_add_u32 m0, s82, 120832
    s_nop 0
    buffer_load_dwordx4 v3, s[32:35], s69 offen lds
    buffer_load_dwordx4 v3, s[32:35], s69 offen offset:1024 lds
    s_waitcnt vmcnt(24)
    s_barrier
    s_mov_b32 s69, 512
    s_add_u32 m0, s77, 32768
    s_nop 0
    buffer_load_dwordx4 v1, s[28:31], s69 offen lds
    buffer_load_dwordx4 v2, s[28:31], s69 offen offset:1024 lds
    s_mov_b32 s69, 16896
    s_add_u32 m0, s77, 34816
    s_nop 0
    buffer_load_dwordx4 v1, s[28:31], s69 offen lds
    buffer_load_dwordx4 v2, s[28:31], s69 offen offset:1024 lds
    s_mov_b32 s69, 787456
    s_add_u32 m0, s82, 65536
    s_nop 0
    buffer_load_dwordx4 v3, s[32:35], s69 offen lds
    buffer_load_dwordx4 v3, s[32:35], s69 offen offset:1024 lds
    s_mov_b32 s69, 812032
    s_add_u32 m0, s82, 67584
    s_nop 0
    buffer_load_dwordx4 v3, s[32:35], s69 offen lds
    buffer_load_dwordx4 v3, s[32:35], s69 offen offset:1024 lds
    s_mov_b32 s69, 836608
    s_add_u32 m0, s82, 69632
    s_nop 0
    buffer_load_dwordx4 v3, s[32:35], s69 offen lds
    buffer_load_dwordx4 v3, s[32:35], s69 offen offset:1024 lds
    s_mov_b32 s69, 861184
    s_add_u32 m0, s82, 71680
    s_nop 0
    buffer_load_dwordx4 v3, s[32:35], s69 offen lds
    buffer_load_dwordx4 v3, s[32:35], s69 offen offset:1024 lds
    s_waitcnt vmcnt(24)
    s_barrier
    s_mov_b32 s69, 640
    s_add_u32 m0, s77, 40960
    s_nop 0
    buffer_load_dwordx4 v1, s[28:31], s69 offen lds
    buffer_load_dwordx4 v2, s[28:31], s69 offen offset:1024 lds
    s_mov_b32 s69, 17024
    s_add_u32 m0, s77, 43008
    s_nop 0
    buffer_load_dwordx4 v1, s[28:31], s69 offen lds
    buffer_load_dwordx4 v2, s[28:31], s69 offen offset:1024 lds
    s_mov_b32 s69, 984064
    s_add_u32 m0, s82, 81920
    s_nop 0
    buffer_load_dwordx4 v3, s[32:35], s69 offen lds
    buffer_load_dwordx4 v3, s[32:35], s69 offen offset:1024 lds
    s_mov_b32 s69, 1008640
    s_add_u32 m0, s82, 83968
    s_nop 0
    buffer_load_dwordx4 v3, s[32:35], s69 offen lds
    buffer_load_dwordx4 v3, s[32:35], s69 offen offset:1024 lds
    s_mov_b32 s69, 1033216
    s_add_u32 m0, s82, 86016
    s_nop 0
    buffer_load_dwordx4 v3, s[32:35], s69 offen lds
    buffer_load_dwordx4 v3, s[32:35], s69 offen offset:1024 lds
    s_mov_b32 s69, 1057792
    s_add_u32 m0, s82, 88064
    s_nop 0
    buffer_load_dwordx4 v3, s[32:35], s69 offen lds
    buffer_load_dwordx4 v3, s[32:35], s69 offen offset:1024 lds
    s_waitcnt vmcnt(24)
    s_barrier
    s_mov_b32 s69, 768
    s_add_u32 m0, s77, 49152
    s_nop 0
    buffer_load_dwordx4 v1, s[28:31], s69 offen lds
    buffer_load_dwordx4 v2, s[28:31], s69 offen offset:1024 lds
    s_mov_b32 s69, 17152
    s_add_u32 m0, s77, 51200
    s_nop 0
    buffer_load_dwordx4 v1, s[28:31], s69 offen lds
    buffer_load_dwordx4 v2, s[28:31], s69 offen offset:1024 lds
    s_mov_b32 s69, 1180672
    s_add_u32 m0, s82, 98304
    s_nop 0
    buffer_load_dwordx4 v3, s[32:35], s69 offen lds
    buffer_load_dwordx4 v3, s[32:35], s69 offen offset:1024 lds
    s_mov_b32 s69, 1205248
    s_add_u32 m0, s82, 100352
    s_nop 0
    buffer_load_dwordx4 v3, s[32:35], s69 offen lds
    buffer_load_dwordx4 v3, s[32:35], s69 offen offset:1024 lds
    s_mov_b32 s69, 1229824
    s_add_u32 m0, s82, 102400
    s_nop 0
    buffer_load_dwordx4 v3, s[32:35], s69 offen lds
    buffer_load_dwordx4 v3, s[32:35], s69 offen offset:1024 lds
    s_mov_b32 s69, 1254400
    s_add_u32 m0, s82, 104448
    s_nop 0
    buffer_load_dwordx4 v3, s[32:35], s69 offen lds
    buffer_load_dwordx4 v3, s[32:35], s69 offen offset:1024 lds
    s_waitcnt vmcnt(24)
    s_barrier
    s_mov_b32 s69, 896
    s_add_u32 m0, s77, 57344
    s_nop 0
    buffer_load_dwordx4 v1, s[28:31], s69 offen lds
    buffer_load_dwordx4 v2, s[28:31], s69 offen offset:1024 lds
    s_mov_b32 s69, 17280
    s_add_u32 m0, s77, 59392
    s_nop 0
    buffer_load_dwordx4 v1, s[28:31], s69 offen lds
    buffer_load_dwordx4 v2, s[28:31], s69 offen offset:1024 lds
    s_mov_b32 s69, 1377280
    s_add_u32 m0, s82, 114688
    s_nop 0
    buffer_load_dwordx4 v3, s[32:35], s69 offen lds
    buffer_load_dwordx4 v3, s[32:35], s69 offen offset:1024 lds
    s_mov_b32 s69, 1401856
    s_add_u32 m0, s82, 116736
    s_nop 0
    buffer_load_dwordx4 v3, s[32:35], s69 offen lds
    buffer_load_dwordx4 v3, s[32:35], s69 offen offset:1024 lds
    s_mov_b32 s69, 1426432
    s_add_u32 m0, s82, 118784
    s_nop 0
    buffer_load_dwordx4 v3, s[32:35], s69 offen lds
    buffer_load_dwordx4 v3, s[32:35], s69 offen offset:1024 lds
    s_mov_b32 s69, 1451008
    s_add_u32 m0, s82, 120832
    s_nop 0
    buffer_load_dwordx4 v3, s[32:35], s69 offen lds
    buffer_load_dwordx4 v3, s[32:35], s69 offen offset:1024 lds
    s_waitcnt vmcnt(24)
    s_barrier
    s_mov_b32 s69, 0
    s_add_u32 m0, s77, 65536
    s_nop 0
    buffer_load_dwordx4 v3, s[32:35], s69 offen lds
    s_mov_b32 s69, 24576
    s_add_u32 m0, s77, 66560
    s_nop 0
    buffer_load_dwordx4 v3, s[32:35], s69 offen lds
    s_mov_b32 s69, 49152
    s_add_u32 m0, s77, 67584
    s_nop 0
    buffer_load_dwordx4 v3, s[32:35], s69 offen lds
    s_mov_b32 s69, 73728
    s_add_u32 m0, s77, 68608
    s_nop 0
    buffer_load_dwordx4 v3, s[32:35], s69 offen lds
    s_mov_b32 s69, 196608
    s_add_u32 m0, s77, 73728
    s_nop 0
    buffer_load_dwordx4 v3, s[32:35], s69 offen lds
    s_mov_b32 s69, 221184
    s_add_u32 m0, s77, 74752
    s_nop 0
    buffer_load_dwordx4 v3, s[32:35], s69 offen lds
    s_mov_b32 s69, 245760
    s_add_u32 m0, s77, 75776
    s_nop 0
    buffer_load_dwordx4 v3, s[32:35], s69 offen lds
    s_mov_b32 s69, 270336
    s_add_u32 m0, s77, 76800
    s_nop 0
    buffer_load_dwordx4 v3, s[32:35], s69 offen lds
    s_waitcnt vmcnt(20)
    s_barrier
    s_mov_b32 s69, 393216
    s_add_u32 m0, s77, 81920
    s_nop 0
    buffer_load_dwordx4 v3, s[32:35], s69 offen lds
    s_mov_b32 s69, 417792
    s_add_u32 m0, s77, 82944
    s_nop 0
    buffer_load_dwordx4 v3, s[32:35], s69 offen lds
    s_mov_b32 s69, 442368
    s_add_u32 m0, s77, 83968
    s_nop 0
    buffer_load_dwordx4 v3, s[32:35], s69 offen lds
    s_mov_b32 s69, 466944
    s_add_u32 m0, s77, 84992
    s_nop 0
    buffer_load_dwordx4 v3, s[32:35], s69 offen lds
    s_mov_b32 s69, 589824
    s_add_u32 m0, s77, 90112
    s_nop 0
    buffer_load_dwordx4 v3, s[32:35], s69 offen lds
    s_mov_b32 s69, 614400
    s_add_u32 m0, s77, 91136
    s_nop 0
    buffer_load_dwordx4 v3, s[32:35], s69 offen lds
    s_mov_b32 s69, 638976
    s_add_u32 m0, s77, 92160
    s_nop 0
    buffer_load_dwordx4 v3, s[32:35], s69 offen lds
    s_mov_b32 s69, 663552
    s_add_u32 m0, s77, 93184
    s_nop 0
    buffer_load_dwordx4 v3, s[32:35], s69 offen lds
    s_waitcnt vmcnt(16)
    s_barrier
    s_mov_b32 s69, 786432
    s_add_u32 m0, s77, 98304
    s_nop 0
    buffer_load_dwordx4 v3, s[32:35], s69 offen lds
    s_mov_b32 s69, 811008
    s_add_u32 m0, s77, 99328
    s_nop 0
    buffer_load_dwordx4 v3, s[32:35], s69 offen lds
    s_mov_b32 s69, 835584
    s_add_u32 m0, s77, 100352
    s_nop 0
    buffer_load_dwordx4 v3, s[32:35], s69 offen lds
    s_mov_b32 s69, 860160
    s_add_u32 m0, s77, 101376
    s_nop 0
    buffer_load_dwordx4 v3, s[32:35], s69 offen lds
    s_mov_b32 s69, 983040
    s_add_u32 m0, s77, 106496
    s_nop 0
    buffer_load_dwordx4 v3, s[32:35], s69 offen lds
    s_mov_b32 s69, 1007616
    s_add_u32 m0, s77, 107520
    s_nop 0
    buffer_load_dwordx4 v3, s[32:35], s69 offen lds
    s_mov_b32 s69, 1032192
    s_add_u32 m0, s77, 108544
    s_nop 0
    buffer_load_dwordx4 v3, s[32:35], s69 offen lds
    s_mov_b32 s69, 1056768
    s_add_u32 m0, s77, 109568
    s_nop 0
    buffer_load_dwordx4 v3, s[32:35], s69 offen lds
    s_barrier
    s_mov_b32 s69, 1179648
    s_add_u32 m0, s77, 114688
    s_nop 0
    buffer_load_dwordx4 v3, s[32:35], s69 offen lds
    s_mov_b32 s69, 1204224
    s_add_u32 m0, s77, 115712
    s_nop 0
    buffer_load_dwordx4 v3, s[32:35], s69 offen lds
    s_mov_b32 s69, 1228800
    s_add_u32 m0, s77, 116736
    s_nop 0
    buffer_load_dwordx4 v3, s[32:35], s69 offen lds
    s_mov_b32 s69, 1253376
    s_add_u32 m0, s77, 117760
    s_nop 0
    buffer_load_dwordx4 v3, s[32:35], s69 offen lds
    s_mov_b32 s69, 1376256
    s_add_u32 m0, s77, 122880
    s_nop 0
    buffer_load_dwordx4 v3, s[32:35], s69 offen lds
    s_mov_b32 s69, 1400832
    s_add_u32 m0, s77, 123904
    s_nop 0
    buffer_load_dwordx4 v3, s[32:35], s69 offen lds
    s_mov_b32 s69, 1425408
    s_add_u32 m0, s77, 124928
    s_nop 0
    buffer_load_dwordx4 v3, s[32:35], s69 offen lds
    s_mov_b32 s69, 1449984
    s_add_u32 m0, s77, 125952
    s_nop 0
    buffer_load_dwordx4 v3, s[32:35], s69 offen lds
    buffer_load_dword v158, v159, s[52:55], 0 offen sc1
    v_mov_b32 v14, v157
    s_waitcnt vmcnt(0)
    v_cmp_gt_u32 vcc, 32, v158
    s_cbranch_vccz L_LF1_OK
    s_mov_b32 s80, 0
L_LF1_SPIN:
    s_sleep 4
    buffer_load_dword v158, v159, s[52:55], 0 offen sc1
    s_add_u32 s80, s80, 1
    s_cmp_gt_u32 s80, 0x20000
    s_cbranch_scc1 L_LF1_OK
    s_waitcnt vmcnt(0)
    v_cmp_gt_u32 vcc, 32, v158
    s_cbranch_vccnz L_LF1_SPIN
L_LF1_OK:
    s_mov_b32 s69, 0
    buffer_load_dwordx4 v[16:19], v4, s[36:39], s69 offen
    buffer_load_dwordx4 v[20:23], v5, s[36:39], s69 offen offset:1024
    buffer_load_dwordx4 v[24:27], v6, s[36:39], s69 offen offset:2048
    s_mov_b32 s69, 44032
    buffer_load_dwordx4 v[28:31], v4, s[36:39], s69 offen
    buffer_load_dwordx4 v[32:35], v5, s[36:39], s69 offen offset:1024
    buffer_load_dwordx4 v[36:39], v6, s[36:39], s69 offen offset:2048
    s_mov_b32 s69, 0
    buffer_load_dwordx4 v[40:43], v7, s[44:47], s69 offen sc1
    buffer_load_dwordx4 v[44:47], v7, s[44:47], s69 offen offset:1024 sc1
    buffer_load_dwordx4 v[48:51], v8, s[44:47], s69 offen offset:2048 sc1
    buffer_load_dwordx4 v[52:55], v8, s[44:47], s69 offen offset:3072 sc1
    s_mov_b32 s69, 131072
    buffer_load_dwordx4 v[56:59], v7, s[44:47], s69 offen sc1
    buffer_load_dwordx4 v[60:63], v7, s[44:47], s69 offen offset:1024 sc1
    buffer_load_dwordx4 v[64:67], v8, s[44:47], s69 offen offset:2048 sc1
    buffer_load_dwordx4 v[68:71], v8, s[44:47], s69 offen offset:3072 sc1
    s_barrier
    s_mov_b32 s69, 176128
    buffer_load_dwordx4 v[72:75], v4, s[36:39], s69 offen
    buffer_load_dwordx4 v[76:79], v5, s[36:39], s69 offen offset:1024
    buffer_load_dwordx4 v[80:83], v6, s[36:39], s69 offen offset:2048
    s_mov_b32 s69, 220160
    buffer_load_dwordx4 v[84:87], v4, s[36:39], s69 offen
    buffer_load_dwordx4 v[88:91], v5, s[36:39], s69 offen offset:1024
    buffer_load_dwordx4 v[92:95], v6, s[36:39], s69 offen offset:2048
    s_mov_b32 s69, 2048
    buffer_load_dwordx4 v[96:99], v7, s[44:47], s69 offen sc1
    buffer_load_dwordx4 v[100:103], v7, s[44:47], s69 offen offset:1024 sc1
    buffer_load_dwordx4 v[104:107], v8, s[44:47], s69 offen offset:2048 sc1
    buffer_load_dwordx4 v[108:111], v8, s[44:47], s69 offen offset:3072 sc1
    s_mov_b32 s69, 133120
    buffer_load_dwordx4 v[112:115], v7, s[44:47], s69 offen sc1
    buffer_load_dwordx4 v[116:119], v7, s[44:47], s69 offen offset:1024 sc1
    buffer_load_dwordx4 v[120:123], v8, s[44:47], s69 offen offset:2048 sc1
    buffer_load_dwordx4 v[124:127], v8, s[44:47], s69 offen offset:3072 sc1
    s_mov_b32 s69, 352256
    buffer_load_dwordx4 v[128:131], v4, s[36:39], s69 offen
    buffer_load_dwordx4 v[132:135], v5, s[36:39], s69 offen offset:1024
    buffer_load_dwordx4 v[136:139], v6, s[36:39], s69 offen offset:2048
    s_mov_b32 s69, 396288
    buffer_load_dwordx4 v[140:143], v4, s[36:39], s69 offen
    buffer_load_dwordx4 v[144:147], v5, s[36:39], s69 offen offset:1024
    buffer_load_dwordx4 v[148:151], v6, s[36:39], s69 offen offset:2048
    s_mov_b32 s69, 4096
    buffer_load_dwordx4 v[152:155], v7, s[44:47], s69 offen sc1
    buffer_load_dwordx4 v[156:159], v7, s[44:47], s69 offen offset:1024 sc1
    buffer_load_dwordx4 v[160:163], v8, s[44:47], s69 offen offset:2048 sc1
    buffer_load_dwordx4 v[164:167], v8, s[44:47], s69 offen offset:3072 sc1
    s_mov_b32 s69, 135168
    buffer_load_dwordx4 v[168:171], v7, s[44:47], s69 offen sc1
    buffer_load_dwordx4 v[172:175], v7, s[44:47], s69 offen offset:1024 sc1
    buffer_load_dwordx4 v[176:179], v8, s[44:47], s69 offen offset:2048 sc1
    buffer_load_dwordx4 v[180:183], v8, s[44:47], s69 offen offset:3072 sc1
    s_mov_b32 s69, 528384
    buffer_load_dwordx4 v[184:187], v4, s[36:39], s69 offen
    buffer_load_dwordx4 v[188:191], v5, s[36:39], s69 offen offset:1024
    buffer_load_dwordx4 v[192:195], v6, s[36:39], s69 offen offset:2048
    s_mov_b32 s69, 572416
    buffer_load_dwordx4 v[196:199], v4, s[36:39], s69 offen
    buffer_load_dwordx4 v[200:203], v5, s[36:39], s69 offen offset:1024
    buffer_load_dwordx4 v[204:207], v6, s[36:39], s69 offen offset:2048
    s_mov_b32 s69, 6144
    buffer_load_dwordx4 v[208:211], v7, s[44:47], s69 offen sc1
    buffer_load_dwordx4 v[212:215], v7, s[44:47], s69 offen offset:1024 sc1
    buffer_load_dwordx4 v[216:219], v8, s[44:47], s69 offen offset:2048 sc1
    buffer_load_dwordx4 v[220:223], v8, s[44:47], s69 offen offset:3072 sc1
    s_mov_b32 s69, 137216
    buffer_load_dwordx4 v[224:227], v7, s[44:47], s69 offen sc1
    buffer_load_dwordx4 v[228:231], v7, s[44:47], s69 offen offset:1024 sc1
    buffer_load_dwordx4 v[232:235], v8, s[44:47], s69 offen offset:2048 sc1
    buffer_load_dwordx4 v[236:239], v8, s[44:47], s69 offen offset:3072 sc1
    s_barrier
    s_waitcnt vmcnt(42)
    s_add_u32 s64, s81, 0
    v_add_u32 v13, s64, v14
    ds_write_b128 v13, v[16:19] offset:0
    ds_write_b128 v13, v[20:23] offset:1024
    ds_write_b128 v13, v[24:27] offset:2048
    ds_write_b128 v13, v[28:31] offset:3072
    ds_write_b128 v13, v[32:35] offset:4096
    ds_write_b128 v13, v[36:39] offset:5120
    s_add_u32 s64, s82, 12288
    v_add_u32 v13, s64, v14
    ds_write_b128 v13, v[40:43] offset:0
    ds_write_b128 v13, v[44:47] offset:1024
    ds_write_b128 v13, v[48:51] offset:2048
    ds_write_b128 v13, v[52:55] offset:3072
    ds_write_b128 v13, v[56:59] offset:4096
    ds_write_b128 v13, v[60:63] offset:5120
    ds_write_b128 v13, v[64:67] offset:6144
    ds_write_b128 v13, v[68:71] offset:7168
    s_waitcnt vmcnt(28)
    s_add_u32 s64, s81, 65536
    v_add_u32 v13, s64, v14
    ds_write_b128 v13, v[72:75] offset:0
    ds_write_b128 v13, v[76:79] offset:1024
    ds_write_b128 v13, v[80:83] offset:2048
    ds_write_b128 v13, v[84:87] offset:3072
    ds_write_b128 v13, v[88:91] offset:4096
    ds_write_b128 v13, v[92:95] offset:5120
    s_add_u32 s64, s82, 77824
    v_add_u32 v13, s64, v14
    ds_write_b128 v13, v[96:99] offset:0
    ds_write_b128 v13, v[100:103] offset:1024
    ds_write_b128 v13, v[104:107] offset:2048
    ds_write_b128 v13, v[108:111] offset:3072
    ds_write_b128 v13, v[112:115] offset:4096
    ds_write_b128 v13, v[116:119] offset:5120
    ds_write_b128 v13, v[120:123] offset:6144
    ds_write_b128 v13, v[124:127] offset:7168
    s_waitcnt lgkmcnt(0)
    s_barrier
    s_cmp_ge_u32 s73, 30
    s_cbranch_scc1 L_LOAD_SP
    s_waitcnt vmcnt(14)
    s_add_u32 s64, s81, 32768
    v_add_u32 v13, s64, v14
    ds_write_b128 v13, v[128:131] offset:0
    ds_write_b128 v13, v[132:135] offset:1024
    ds_write_b128 v13, v[136:139] offset:2048
    ds_write_b128 v13, v[140:143] offset:3072
    ds_write_b128 v13, v[144:147] offset:4096
    ds_write_b128 v13, v[148:151] offset:5120
    s_add_u32 s64, s82, 45056
    v_add_u32 v13, s64, v14
    ds_write_b128 v13, v[152:155] offset:0
    ds_write_b128 v13, v[156:159] offset:1024
    ds_write_b128 v13, v[160:163] offset:2048
    ds_write_b128 v13, v[164:167] offset:3072
    ds_write_b128 v13, v[168:171] offset:4096
    ds_write_b128 v13, v[172:175] offset:5120
    ds_write_b128 v13, v[176:179] offset:6144
    ds_write_b128 v13, v[180:183] offset:7168
    s_waitcnt vmcnt(0)
    s_add_u32 s64, s81, 98304
    v_add_u32 v13, s64, v14
    ds_write_b128 v13, v[184:187] offset:0
    ds_write_b128 v13, v[188:191] offset:1024
    ds_write_b128 v13, v[192:195] offset:2048
    ds_write_b128 v13, v[196:199] offset:3072
    ds_write_b128 v13, v[200:203] offset:4096
    ds_write_b128 v13, v[204:207] offset:5120
    s_add_u32 s64, s82, 110592
    v_add_u32 v13, s64, v14
    ds_write_b128 v13, v[208:211] offset:0
    ds_write_b128 v13, v[212:215] offset:1024
    ds_write_b128 v13, v[216:219] offset:2048
    ds_write_b128 v13, v[220:223] offset:3072
    ds_write_b128 v13, v[224:227] offset:4096
    ds_write_b128 v13, v[228:231] offset:5120
    ds_write_b128 v13, v[232:235] offset:6144
    ds_write_b128 v13, v[236:239] offset:7168
    s_waitcnt lgkmcnt(0)
    s_barrier
    s_mov_b32 s69, 704512
    s_add_u32 m0, s81, 0
    s_nop 0
    buffer_load_dwordx4 v4, s[36:39], s69 offen lds
    buffer_load_dwordx4 v5, s[36:39], s69 offen offset:1024 lds
    buffer_load_dwordx4 v6, s[36:39], s69 offen offset:2048 lds
    s_mov_b32 s69, 748544
    s_add_u32 m0, s81, 3072
    s_nop 0
    buffer_load_dwordx4 v4, s[36:39], s69 offen lds
    buffer_load_dwordx4 v5, s[36:39], s69 offen offset:1024 lds
    buffer_load_dwordx4 v6, s[36:39], s69 offen offset:2048 lds
    s_mov_b32 s69, 8192
    s_add_u32 m0, s82, 12288
    s_nop 0
    buffer_load_dwordx4 v7, s[44:47], s69 offen sc1 lds
    buffer_load_dwordx4 v7, s[44:47], s69 offen offset:1024 sc1 lds
    buffer_load_dwordx4 v8, s[44:47], s69 offen offset:2048 sc1 lds
    buffer_load_dwordx4 v8, s[44:47], s69 offen offset:3072 sc1 lds
    s_mov_b32 s69, 139264
    s_add_u32 m0, s82, 16384
    s_nop 0
    buffer_load_dwordx4 v7, s[44:47], s69 offen sc1 lds
    buffer_load_dwordx4 v7, s[44:47], s69 offen offset:1024 sc1 lds
    buffer_load_dwordx4 v8, s[44:47], s69 offen offset:2048 sc1 lds
    buffer_load_dwordx4 v8, s[44:47], s69 offen offset:3072 sc1 lds
    s_barrier
    s_mov_b32 s69, 880640
    s_add_u32 m0, s81, 65536
    s_nop 0
    buffer_load_dwordx4 v4, s[36:39], s69 offen lds
    buffer_load_dwordx4 v5, s[36:39], s69 offen offset:1024 lds
    buffer_load_dwordx4 v6, s[36:39], s69 offen offset:2048 lds
    s_mov_b32 s69, 924672
    s_add_u32 m0, s81, 68608
    s_nop 0
    buffer_load_dwordx4 v4, s[36:39], s69 offen lds
    buffer_load_dwordx4 v5, s[36:39], s69 offen offset:1024 lds
    buffer_load_dwordx4 v6, s[36:39], s69 offen offset:2048 lds
    s_mov_b32 s69, 10240
    s_add_u32 m0, s82, 77824
    s_nop 0
    buffer_load_dwordx4 v7, s[44:47], s69 offen sc1 lds
    buffer_load_dwordx4 v7, s[44:47], s69 offen offset:1024 sc1 lds
    buffer_load_dwordx4 v8, s[44:47], s69 offen offset:2048 sc1 lds
    buffer_load_dwordx4 v8, s[44:47], s69 offen offset:3072 sc1 lds
    s_mov_b32 s69, 141312
    s_add_u32 m0, s82, 81920
    s_nop 0
    buffer_load_dwordx4 v7, s[44:47], s69 offen sc1 lds
    buffer_load_dwordx4 v7, s[44:47], s69 offen offset:1024 sc1 lds
    buffer_load_dwordx4 v8, s[44:47], s69 offen offset:2048 sc1 lds
    buffer_load_dwordx4 v8, s[44:47], s69 offen offset:3072 sc1 lds
    s_barrier
    s_mov_b32 s69, 1056768
    s_add_u32 m0, s81, 32768
    s_nop 0
    buffer_load_dwordx4 v4, s[36:39], s69 offen lds
    buffer_load_dwordx4 v5, s[36:39], s69 offen offset:1024 lds
    buffer_load_dwordx4 v6, s[36:39], s69 offen offset:2048 lds
    s_mov_b32 s69, 1100800
    s_add_u32 m0, s81, 35840
    s_nop 0
    buffer_load_dwordx4 v4, s[36:39], s69 offen lds
    buffer_load_dwordx4 v5, s[36:39], s69 offen offset:1024 lds
    buffer_load_dwordx4 v6, s[36:39], s69 offen offset:2048 lds
    s_mov_b32 s69, 12288
    s_add_u32 m0, s82, 45056
    s_nop 0
    buffer_load_dwordx4 v7, s[44:47], s69 offen sc1 lds
    buffer_load_dwordx4 v7, s[44:47], s69 offen offset:1024 sc1 lds
    buffer_load_dwordx4 v8, s[44:47], s69 offen offset:2048 sc1 lds
    buffer_load_dwordx4 v8, s[44:47], s69 offen offset:3072 sc1 lds
    s_mov_b32 s69, 143360
    s_add_u32 m0, s82, 49152
    s_nop 0
    buffer_load_dwordx4 v7, s[44:47], s69 offen sc1 lds
    buffer_load_dwordx4 v7, s[44:47], s69 offen offset:1024 sc1 lds
    buffer_load_dwordx4 v8, s[44:47], s69 offen offset:2048 sc1 lds
    buffer_load_dwordx4 v8, s[44:47], s69 offen offset:3072 sc1 lds
    s_waitcnt vmcnt(28)
    s_barrier
    s_mov_b32 s69, 1232896
    s_add_u32 m0, s81, 98304
    s_nop 0
    buffer_load_dwordx4 v4, s[36:39], s69 offen lds
    buffer_load_dwordx4 v5, s[36:39], s69 offen offset:1024 lds
    buffer_load_dwordx4 v6, s[36:39], s69 offen offset:2048 lds
    s_mov_b32 s69, 1276928
    s_add_u32 m0, s81, 101376
    s_nop 0
    buffer_load_dwordx4 v4, s[36:39], s69 offen lds
    buffer_load_dwordx4 v5, s[36:39], s69 offen offset:1024 lds
    buffer_load_dwordx4 v6, s[36:39], s69 offen offset:2048 lds
    s_mov_b32 s69, 14336
    s_add_u32 m0, s82, 110592
    s_nop 0
    buffer_load_dwordx4 v7, s[44:47], s69 offen sc1 lds
    buffer_load_dwordx4 v7, s[44:47], s69 offen offset:1024 sc1 lds
    buffer_load_dwordx4 v8, s[44:47], s69 offen offset:2048 sc1 lds
    buffer_load_dwordx4 v8, s[44:47], s69 offen offset:3072 sc1 lds
    s_mov_b32 s69, 145408
    s_add_u32 m0, s82, 114688
    s_nop 0
    buffer_load_dwordx4 v7, s[44:47], s69 offen sc1 lds
    buffer_load_dwordx4 v7, s[44:47], s69 offen offset:1024 sc1 lds
    buffer_load_dwordx4 v8, s[44:47], s69 offen offset:2048 sc1 lds
    buffer_load_dwordx4 v8, s[44:47], s69 offen offset:3072 sc1 lds
    s_waitcnt vmcnt(28)
    s_barrier
    s_waitcnt vmcnt(14)
    s_mov_b32 s69, 524288
    s_add_u32 m0, s77, 131072
    s_nop 0
    buffer_load_dwordx4 v9, s[56:59], s69 offen lds
    buffer_load_dwordx4 v10, s[56:59], s69 offen offset:1024 lds
    s_mov_b32 s69, 1966080
    s_add_u32 m0, s77, 133120
    s_nop 0
    buffer_load_dwordx4 v9, s[56:59], s69 offen lds
    buffer_load_dwordx4 v10, s[56:59], s69 offen offset:1024 lds
    s_mov_b32 s69, 589824
    s_add_u32 m0, s77, 139264
    s_nop 0
    buffer_load_dwordx4 v9, s[56:59], s69 offen lds
    buffer_load_dwordx4 v10, s[56:59], s69 offen offset:1024 lds
    s_mov_b32 s69, 2031616
    s_add_u32 m0, s77, 141312
    s_nop 0
    buffer_load_dwordx4 v9, s[56:59], s69 offen lds
    buffer_load_dwordx4 v10, s[56:59], s69 offen offset:1024 lds
    s_mov_b32 s69, 655360
    s_add_u32 m0, s77, 147456
    s_nop 0
    buffer_load_dwordx4 v9, s[56:59], s69 offen lds
    buffer_load_dwordx4 v10, s[56:59], s69 offen offset:1024 lds
    s_mov_b32 s69, 2097152
    s_add_u32 m0, s77, 149504
    s_nop 0
    buffer_load_dwordx4 v9, s[56:59], s69 offen lds
    buffer_load_dwordx4 v10, s[56:59], s69 offen offset:1024 lds
    s_mov_b32 s69, 720896
    s_add_u32 m0, s77, 155648
    s_nop 0
    buffer_load_dwordx4 v9, s[56:59], s69 offen lds
    buffer_load_dwordx4 v10, s[56:59], s69 offen offset:1024 lds
    s_mov_b32 s69, 2162688
    s_add_u32 m0, s77, 157696
    s_nop 0
    buffer_load_dwordx4 v9, s[56:59], s69 offen lds
    buffer_load_dwordx4 v10, s[56:59], s69 offen offset:1024 lds
    s_waitcnt vmcnt(30)
    s_barrier
    s_waitcnt vmcnt(16)
    s_mov_b32 s69, 0
    s_add_u32 m0, s77, 65536
    s_nop 0
    buffer_load_dwordx4 v9, s[56:59], s69 offen lds
    buffer_load_dwordx4 v10, s[56:59], s69 offen offset:1024 lds
    s_mov_b32 s69, 1441792
    s_add_u32 m0, s77, 67584
    s_nop 0
    buffer_load_dwordx4 v9, s[56:59], s69 offen lds
    buffer_load_dwordx4 v10, s[56:59], s69 offen offset:1024 lds
    s_mov_b32 s69, 65536
    s_add_u32 m0, s77, 73728
    s_nop 0
    buffer_load_dwordx4 v9, s[56:59], s69 offen lds
    buffer_load_dwordx4 v10, s[56:59], s69 offen offset:1024 lds
    s_mov_b32 s69, 1507328
    s_add_u32 m0, s77, 75776
    s_nop 0
    buffer_load_dwordx4 v9, s[56:59], s69 offen lds
    buffer_load_dwordx4 v10, s[56:59], s69 offen offset:1024 lds
    s_mov_b32 s69, 131072
    s_add_u32 m0, s77, 81920
    s_nop 0
    buffer_load_dwordx4 v9, s[56:59], s69 offen lds
    buffer_load_dwordx4 v10, s[56:59], s69 offen offset:1024 lds
    s_mov_b32 s69, 1572864
    s_add_u32 m0, s77, 83968
    s_nop 0
    buffer_load_dwordx4 v9, s[56:59], s69 offen lds
    buffer_load_dwordx4 v10, s[56:59], s69 offen offset:1024 lds
    s_mov_b32 s69, 196608
    s_add_u32 m0, s77, 90112
    s_nop 0
    buffer_load_dwordx4 v9, s[56:59], s69 offen lds
    buffer_load_dwordx4 v10, s[56:59], s69 offen offset:1024 lds
    s_mov_b32 s69, 1638400
    s_add_u32 m0, s77, 92160
    s_nop 0
    buffer_load_dwordx4 v9, s[56:59], s69 offen lds
    buffer_load_dwordx4 v10, s[56:59], s69 offen offset:1024 lds
    s_waitcnt vmcnt(32)
    s_barrier
    s_branch L_LOAD_E
L_LOAD_SP:
    s_mov_b32 s69, 0
    s_add_u32 m0, s77, 65536
    s_nop 0
    buffer_load_dwordx4 v9, s[56:59], s69 offen lds
    buffer_load_dwordx4 v10, s[56:59], s69 offen offset:1024 lds
    s_mov_b32 s69, 1441792
    s_add_u32 m0, s77, 67584
    s_nop 0
    buffer_load_dwordx4 v9, s[56:59], s69 offen lds
    buffer_load_dwordx4 v10, s[56:59], s69 offen offset:1024 lds
    s_mov_b32 s69, 65536
    s_add_u32 m0, s77, 73728
    s_nop 0
    buffer_load_dwordx4 v9, s[56:59], s69 offen lds
    buffer_load_dwordx4 v10, s[56:59], s69 offen offset:1024 lds
    s_mov_b32 s69, 1507328
    s_add_u32 m0, s77, 75776
    s_nop 0
    buffer_load_dwordx4 v9, s[56:59], s69 offen lds
    buffer_load_dwordx4 v10, s[56:59], s69 offen offset:1024 lds
    s_mov_b32 s69, 131072
    s_add_u32 m0, s77, 81920
    s_nop 0
    buffer_load_dwordx4 v9, s[56:59], s69 offen lds
    buffer_load_dwordx4 v10, s[56:59], s69 offen offset:1024 lds
    s_mov_b32 s69, 1572864
    s_add_u32 m0, s77, 83968
    s_nop 0
    buffer_load_dwordx4 v9, s[56:59], s69 offen lds
    buffer_load_dwordx4 v10, s[56:59], s69 offen offset:1024 lds
    s_mov_b32 s69, 196608
    s_add_u32 m0, s77, 90112
    s_nop 0
    buffer_load_dwordx4 v9, s[56:59], s69 offen lds
    buffer_load_dwordx4 v10, s[56:59], s69 offen offset:1024 lds
    s_mov_b32 s69, 1638400
    s_add_u32 m0, s77, 92160
    s_nop 0
    buffer_load_dwordx4 v9, s[56:59], s69 offen lds
    buffer_load_dwordx4 v10, s[56:59], s69 offen offset:1024 lds
    s_barrier
    s_mov_b32 s69, 524288
    s_add_u32 m0, s77, 131072
    s_nop 0
    buffer_load_dwordx4 v9, s[56:59], s69 offen lds
    buffer_load_dwordx4 v10, s[56:59], s69 offen offset:1024 lds
    s_mov_b32 s69, 1966080
    s_add_u32 m0, s77, 133120
    s_nop 0
    buffer_load_dwordx4 v9, s[56:59], s69 offen lds
    buffer_load_dwordx4 v10, s[56:59], s69 offen offset:1024 lds
    s_mov_b32 s69, 589824
    s_add_u32 m0, s77, 139264
    s_nop 0
    buffer_load_dwordx4 v9, s[56:59], s69 offen lds
    buffer_load_dwordx4 v10, s[56:59], s69 offen offset:1024 lds
    s_mov_b32 s69, 2031616
    s_add_u32 m0, s77, 141312
    s_nop 0
    buffer_load_dwordx4 v9, s[56:59], s69 offen lds
    buffer_load_dwordx4 v10, s[56:59], s69 offen offset:1024 lds
    s_mov_b32 s69, 655360
    s_add_u32 m0, s77, 147456
    s_nop 0
    buffer_load_dwordx4 v9, s[56:59], s69 offen lds
    buffer_load_dwordx4 v10, s[56:59], s69 offen offset:1024 lds
    s_mov_b32 s69, 2097152
    s_add_u32 m0, s77, 149504
    s_nop 0
    buffer_load_dwordx4 v9, s[56:59], s69 offen lds
    buffer_load_dwordx4 v10, s[56:59], s69 offen offset:1024 lds
    s_mov_b32 s69, 720896
    s_add_u32 m0, s77, 155648
    s_nop 0
    buffer_load_dwordx4 v9, s[56:59], s69 offen lds
    buffer_load_dwordx4 v10, s[56:59], s69 offen offset:1024 lds
    s_mov_b32 s69, 2162688
    s_add_u32 m0, s77, 157696
    s_nop 0
    buffer_load_dwordx4 v9, s[56:59], s69 offen lds
    buffer_load_dwordx4 v10, s[56:59], s69 offen offset:1024 lds
    s_branch L_LOAD_F
L_LOAD_E:
    s_barrier
L_LOAD_F:
    s_mov_b32 s69, 0
    s_add_u32 m0, s77, 0
    s_nop 0
    buffer_load_dwordx4 v11, s[48:51], s69 offen lds
    buffer_load_dwordx4 v12, s[48:51], s69 offen offset:1024 lds
    s_mov_b32 s69, 131072
    s_add_u32 m0, s77, 2048
    s_nop 0
    buffer_load_dwordx4 v11, s[48:51], s69 offen lds
    buffer_load_dwordx4 v12, s[48:51], s69 offen offset:1024 lds
    s_mov_b32 s69, 16384
    s_add_u32 m0, s77, 8192
    s_nop 0
    buffer_load_dwordx4 v11, s[48:51], s69 offen lds
    buffer_load_dwordx4 v12, s[48:51], s69 offen offset:1024 lds
    s_mov_b32 s69, 147456
    s_add_u32 m0, s77, 10240
    s_nop 0
    buffer_load_dwordx4 v11, s[48:51], s69 offen lds
    buffer_load_dwordx4 v12, s[48:51], s69 offen offset:1024 lds
    s_mov_b32 s69, 32768
    s_add_u32 m0, s77, 16384
    s_nop 0
    buffer_load_dwordx4 v11, s[48:51], s69 offen lds
    buffer_load_dwordx4 v12, s[48:51], s69 offen offset:1024 lds
    s_mov_b32 s69, 163840
    s_add_u32 m0, s77, 18432
    s_nop 0
    buffer_load_dwordx4 v11, s[48:51], s69 offen lds
    buffer_load_dwordx4 v12, s[48:51], s69 offen offset:1024 lds
    s_mov_b32 s69, 49152
    s_add_u32 m0, s77, 24576
    s_nop 0
    buffer_load_dwordx4 v11, s[48:51], s69 offen lds
    buffer_load_dwordx4 v12, s[48:51], s69 offen offset:1024 lds
    s_mov_b32 s69, 180224
    s_add_u32 m0, s77, 26624
    s_nop 0
    buffer_load_dwordx4 v11, s[48:51], s69 offen lds
    buffer_load_dwordx4 v12, s[48:51], s69 offen offset:1024 lds
    s_mov_b32 s69, 65536
    s_add_u32 m0, s77, 32768
    s_nop 0
    buffer_load_dwordx4 v11, s[48:51], s69 offen lds
    buffer_load_dwordx4 v12, s[48:51], s69 offen offset:1024 lds
    s_mov_b32 s69, 196608
    s_add_u32 m0, s77, 34816
    s_nop 0
    buffer_load_dwordx4 v11, s[48:51], s69 offen lds
    buffer_load_dwordx4 v12, s[48:51], s69 offen offset:1024 lds
    s_mov_b32 s69, 81920
    s_add_u32 m0, s77, 40960
    s_nop 0
    buffer_load_dwordx4 v11, s[48:51], s69 offen lds
    buffer_load_dwordx4 v12, s[48:51], s69 offen offset:1024 lds
    s_mov_b32 s69, 212992
    s_add_u32 m0, s77, 43008
    s_nop 0
    buffer_load_dwordx4 v11, s[48:51], s69 offen lds
    buffer_load_dwordx4 v12, s[48:51], s69 offen offset:1024 lds
    s_mov_b32 s69, 98304
    s_add_u32 m0, s77, 49152
    s_nop 0
    buffer_load_dwordx4 v11, s[48:51], s69 offen lds
    buffer_load_dwordx4 v12, s[48:51], s69 offen offset:1024 lds
    s_mov_b32 s69, 229376
    s_add_u32 m0, s77, 51200
    s_nop 0
    buffer_load_dwordx4 v11, s[48:51], s69 offen lds
    buffer_load_dwordx4 v12, s[48:51], s69 offen offset:1024 lds
    s_mov_b32 s69, 114688
    s_add_u32 m0, s77, 57344
    s_nop 0
    buffer_load_dwordx4 v11, s[48:51], s69 offen lds
    buffer_load_dwordx4 v12, s[48:51], s69 offen offset:1024 lds
    s_mov_b32 s69, 245760
    s_add_u32 m0, s77, 59392
    s_nop 0
    buffer_load_dwordx4 v11, s[48:51], s69 offen lds
    buffer_load_dwordx4 v12, s[48:51], s69 offen offset:1024 lds
    s_mov_b32 s69, 262144
    s_add_u32 m0, s77, 98304
    s_nop 0
    buffer_load_dwordx4 v9, s[56:59], s69 offen lds
    buffer_load_dwordx4 v10, s[56:59], s69 offen offset:1024 lds
    s_mov_b32 s69, 1703936
    s_add_u32 m0, s77, 100352
    s_nop 0
    buffer_load_dwordx4 v9, s[56:59], s69 offen lds
    buffer_load_dwordx4 v10, s[56:59], s69 offen offset:1024 lds
    s_mov_b32 s69, 327680
    s_add_u32 m0, s77, 106496
    s_nop 0
    buffer_load_dwordx4 v9, s[56:59], s69 offen lds
    buffer_load_dwordx4 v10, s[56:59], s69 offen offset:1024 lds
    s_mov_b32 s69, 1769472
    s_add_u32 m0, s77, 108544
    s_nop 0
    buffer_load_dwordx4 v9, s[56:59], s69 offen lds
    buffer_load_dwordx4 v10, s[56:59], s69 offen offset:1024 lds
    s_mov_b32 s69, 393216
    s_add_u32 m0, s77, 114688
    s_nop 0
    buffer_load_dwordx4 v9, s[56:59], s69 offen lds
    buffer_load_dwordx4 v10, s[56:59], s69 offen offset:1024 lds
    s_mov_b32 s69, 1835008
    s_add_u32 m0, s77, 116736
    s_nop 0
    buffer_load_dwordx4 v9, s[56:59], s69 offen lds
    buffer_load_dwordx4 v10, s[56:59], s69 offen offset:1024 lds
    s_mov_b32 s69, 458752
    s_add_u32 m0, s77, 122880
    s_nop 0
    buffer_load_dwordx4 v9, s[56:59], s69 offen lds
    buffer_load_dwordx4 v10, s[56:59], s69 offen offset:1024 lds
    s_mov_b32 s69, 1900544
    s_add_u32 m0, s77, 124928
    s_nop 0
    buffer_load_dwordx4 v9, s[56:59], s69 offen lds
    buffer_load_dwordx4 v10, s[56:59], s69 offen offset:1024 lds
    s_waitcnt vmcnt(0)
    s_barrier
    s_endpgm
L_HELP:
    s_mov_b32 s50, L_CODE_END-L_PC
    s_mov_b32 s51, 0x20000
    s_and_b32 s3, s73, 15
    s_mul_i32 s3, s3, 2560
    v_lshlrev_b32 v1, 7, v144
    v_min_u32 v5, 2432, v1
    buffer_load_dword v128, v5, s[48:51], s3 offen
    v_bfe_u32 v2, v144, 2, 3
    v_lshlrev_b32 v2, 10, v2
    v_and_b32 v3, 3, v144
    v_lshl_add_u32 v2, v3, 7, v2
    v_lshrrev_b32 v4, 2, v144
    v_mul_u32_u24 v6, 3072, v4
    v_lshl_add_u32 v6, v3, 7, v6
    v_bfe_u32 v4, v144, 2, 1
    v_lshlrev_b32 v4, 10, v4
    v_lshl_add_u32 v3, v3, 7, v4
    v_lshrrev_b32 v4, 3, v144
    v_mul_u32_u24 v4, 3072, v4
    v_add_u32 v3, v3, v4
    s_lshr_b32 s75, s72, 1
    s_xor_b32 s76, s72, 1
    s_lshl_b32 s76, s76, 5
    s_add_u32 s76, s76, s73
    s_lshl_b32 s76, s76, 13
    s_mul_i32 s77, s73, 24576
    s_and_b32 s64, s72, 1
    s_lshl_b32 s66, s64, 9
    s_lshl_b32 s74, s77, 1
    s_add_u32 s74, s74, s66
    s_add_u32 s77, s77, s66
    s_add_u32 s77, s77, 1024
    v_and_b32 v4, 15, v144
    v_lshlrev_b32 v4, 7, v4
    v_min_u32 v4, 1532, v4
    v_lshrrev_b32 v5, 4, v144
    v_mul_u32_u24 v5, 2752, v5
    v_add_u32 v4, v4, v5
    s_lshl_b32 s78, s75, 9
    s_lshl_b32 s66, s73, 2
    s_add_u32 s78, s78, s66
    s_mul_i32 s78, s78, 2752
    s_mul_i32 s64, s64, 1344
    s_add_u32 s78, s78, s64
    v_and_b32 v7, 15, v144
    v_lshlrev_b32 v7, 7, v7
    v_min_u32 v7, 1532, v7
    v_bfe_u32 v5, v144, 4, 1
    v_mul_u32_u24 v5, 2752, v5
    v_add_u32 v7, v7, v5
    v_min_u32 v8, 2688, v1
    s_mul_i32 s66, s73, 5504
    s_sub_u32 s86, s78, s66
    s_mov_b32 s87, 0
    s_mul_i32 s65, s2, 22016
    s_lshl_b32 s66, s2, 11
    s_waitcnt lgkmcnt(0)
    s_mov_b32 s28, s4
    s_mov_b32 s29, s5
    s_mov_b32 s30, 2097152
    s_mov_b32 s31, 0x20000
    s_mov_b32 s32, s6
    s_mov_b32 s33, s7
    s_mov_b32 s34, 1572864
    s_mov_b32 s35, 0x20000
    buffer_load_dword v128, v3, s[32:35], s77 offen
    s_add_u32 s77, s77, 786432
    buffer_load_dword v128, v2, s[28:31], s76 offen
    s_mov_b32 s36, s14
    s_mov_b32 s37, s15
    s_mov_b32 s38, 5636096
    s_mov_b32 s39, 0x20000
    s_add_u32 s40, s18, s65
    s_addc_u32 s41, s19, 0
    s_mov_b32 s42, 22016
    s_mov_b32 s43, 0x20000
    s_add_u32 s44, s10, s66
    s_addc_u32 s45, s11, 0
    s_mov_b32 s46, 2048
    s_mov_b32 s47, 0x20000
    buffer_load_dword v128, v3, s[32:35], s77 offen
    s_add_u32 s77, s77, 786432
    buffer_load_dword v128, v2, s[28:31], s76 offen offset:512
    s_barrier
    s_barrier
    s_barrier
    buffer_load_dword v128, v6, s[32:35], s74 offen
    s_barrier
    s_barrier
    s_barrier
    s_barrier
    s_barrier
    buffer_load_dword v128, v4, s[36:39], s78 offen
    s_add_u32 s78, s78, 352256
    buffer_load_dword v128, v4, s[36:39], s78 offen
    s_add_u32 s78, s78, 352256
    buffer_load_dword v128, v4, s[36:39], s78 offen
    s_add_u32 s78, s78, 352256
    buffer_load_dword v128, v4, s[36:39], s78 offen
    s_add_u32 s78, s78, 352256
    s_barrier
    s_barrier
    s_barrier
    s_mov_b32 s64, 0
    buffer_load_dword v128, v1, s[40:43], s64 offen
    s_mov_b32 s64, 8192
    buffer_load_dword v128, v1, s[40:43], s64 offen
    s_mov_b32 s64, 16384
    buffer_load_dword v128, v1, s[40:43], s64 offen
    buffer_load_dword v128, v1, s[44:47], 0 offen
    s_barrier
    s_endpgm
L_CODE_END:
    s_endpgm
.section .rodata,"a"
.p2align 6
.amdhsa_kernel parallel_sum__linear_kernel_hedgehog__mixer_token_mlp__prompt_kernel
  .amdhsa_next_free_vgpr 256
  .amdhsa_next_free_sgpr 102
  .amdhsa_accum_offset 256
  .amdhsa_group_segment_fixed_size 0
  .amdhsa_kernarg_size 96
  .amdhsa_user_sgpr_count 2
  .amdhsa_user_sgpr_kernarg_segment_ptr 1
  .amdhsa_system_sgpr_workgroup_id_x 1
  .amdhsa_float_denorm_mode_32 3
.end_amdhsa_kernel
```
